```python
import torch

def _softmax(x, axis=-1):
    return torch.softmax(x, dim=axis)
def _gelu(x):
    return torch.nn.functional.gelu(x, approximate="tanh")
def _silu(x):
    return torch.nn.functional.silu(x)
def _sigmoid(x):
    return torch.sigmoid(x)
def _layernorm(x, axis=-1, eps=1e-5):
    m = x.mean(dim=axis, keepdim=True)
    v = x.var(dim=axis, keepdim=True, unbiased=False)
    return (x - m) / torch.sqrt(v + eps)
def _scatter_add(tgt, idx, src, axis=0):
    return tgt.clone().index_add_(axis, idx, src)
def _segment_sum(src, seg, n):
    out = torch.zeros((n,) + src.shape[1:], dtype=src.dtype)
    return out.index_add_(0, seg, src)
def _pad(x, pw):
    flat = tuple(v for pair in reversed(pw) for v in pair)
    return torch.nn.functional.pad(x, flat)

kernel_name = 'gated_mix__mha_block__sliding_local_dilated__prompt'

def setup_inputs():

    _w = (lambda a: (lambda t: t.to(torch.bfloat16) if t.is_floating_point() else t)(torch.as_tensor(a)))
    def _A_setup():
        B, S, D, H = 1, 2048, 1024, 32
        return {
            "x": _w((lambda *s: torch.randn(*s, dtype=torch.bfloat16) * 0.05)(B, S, D)),
            "wqkv": _w((lambda *s: torch.randn(*s, dtype=torch.bfloat16) * 0.8)(D, 3 * D)),
            "wo": _w((lambda *s: torch.randn(*s, dtype=torch.bfloat16) * 0.1)(D, D)),
        }
    _A_in = _A_setup()

    def _B_setup():
        B, S, D = 1, 2048, 1024
        return {
            "x": _w((lambda *s: torch.randn(*s, dtype=torch.bfloat16) * 0.05)(B, S, D)),
            "wqkv": _w((lambda *s: torch.randn(*s, dtype=torch.bfloat16) * 0.8)(D, 3 * D)),
            "wo": _w((lambda *s: torch.randn(*s, dtype=torch.bfloat16) * 0.05)(D, D)),
        }
    _B_in = _B_setup()

    return {
        "A_x": _A_in["x"],
        "A_wqkv": _A_in["wqkv"],
        "A_wo": _A_in["wo"],
        "B_x": _B_in["x"],
        "B_wqkv": _B_in["wqkv"],
        "B_wo": _B_in["wo"],
        "gate_w": _w((lambda *s: torch.randn(*s, dtype=torch.bfloat16) * 0.05)(1024) * 16.0),
    }

def reference(A_x, A_wqkv, A_wo, B_x, B_wqkv, B_wo, gate_w):
    def _A_ref(x, wqkv, wo):
        B, S, D = x.shape
        H = 32
        Dh = D // H
        qkv = (lambda x, *d: x.permute(*d))((x @ wqkv).reshape(B, S, 3, H, Dh), 2, 0, 3, 1, 4)
        q, k, v = qkv[0], qkv[1], qkv[2]
        scores = torch.einsum("bhqd,bhkd->bhqk", q, k) * (Dh ** -0.5)
        p = _softmax(scores, axis=-1)
        o = torch.einsum("bhqk,bhkd->bhqd", p, v)
        return (lambda x, *d: x.permute(*d))(o, 0, 2, 1, 3).reshape(B, S, D) @ wo

    def _B_ref(x, wqkv, wo):
        B, S, D = x.shape
        H = 32; Dh = D // H
        W, dil = 8, 2
        qkv = (lambda x, *d: x.permute(*d))((x @ wqkv).reshape(B, S, 3, H, Dh), 2, 0, 3, 1, 4)
        q, k, v = qkv[0], qkv[1], qkv[2]
        scale = Dh ** -0.5
        pos = torch.arange(S)
        off = torch.arange(W) * dil
        idx = pos[:, None] - off[None, :]
        mask = idx >= 0
        idx_c = torch.where(mask, idx, 0).reshape(-1)
        kg = k[:, :, idx_c, :].reshape(B, H, S, W, Dh)
        vg = v[:, :, idx_c, :].reshape(B, H, S, W, Dh)
        logits = torch.einsum("bhsd,bhswd->bhsw", q, kg) * scale
        logits = torch.where(mask[None, None, :, :], logits, -1e9)
        attn = _softmax(logits, axis=-1)
        o = torch.einsum("bhsw,bhswd->bhsd", attn, vg)
        return (lambda x, *d: x.permute(*d))(o, 0, 2, 1, 3).reshape(B, S, D) @ wo

    x = A_x
    g = _sigmoid((x * gate_w).sum(-1, keepdims=True))
    a = _A_ref(x, A_wqkv, A_wo)
    b = _B_ref(x, B_wqkv, B_wo)
    return g * a + (1 - g) * b
```

```asm
; @launch grid=(256,1,1) block=(512,1,1) lds=163840
.amdgcn_target "amdgcn-amd-amdhsa--gfx950"
.text
.globl gated_mix__mha_block__sliding_local_dilated__prompt_kernel
.p2align 8
.type gated_mix__mha_block__sliding_local_dilated__prompt_kernel,@function
gated_mix__mha_block__sliding_local_dilated__prompt_kernel:
    s_cmp_ge_u32 s2, 256
    s_cbranch_scc1 L_end
    s_load_dwordx16 s[32:47], s[0:1], 0
    s_load_dwordx4 s[48:51], s[0:1], 64
    s_and_b32 s60, s2, 7
    s_lshr_b32 s61, s2, 3
    s_and_b32 s25, s61, 3
    s_lshl_b32 s60, s60, 1
    s_and_b32 s20, s25, 1
    s_add_u32 s60, s60, s20
    s_lshr_b32 s20, s25, 1
    s_lshl_b32 s20, s20, 4
    s_add_u32 s20, s20, s60
    s_lshr_b32 s21, s61, 2
    v_lshrrev_b32 v204, 6, v0
    v_and_b32 v255, 63, v0
    v_readfirstlane_b32 s22, v204
    v_lshlrev_b32 v254, 4, v255
    v_mov_b32 v205, 0x7fffff00
    v_cmp_eq_u32 vcc, 0, v255
    s_lshr_b32 s23, s22, 2
    s_and_b32 s24, s22, 3
    v_cndmask_b32_e64 v253, v205, 0, vcc
    v_lshrrev_b32 v204, 2, v255
    s_lshl_b32 s60, s24, 4
    v_add_u32 v204, s60, v204
    s_movk_i32 s60, 6144
    v_mul_lo_u32 v204, v204, s60
    v_and_b32 v205, 3, v255
    v_lshrrev_b32 v206, 5, v255
    v_lshlrev_b32 v206, 1, v206
    v_xor_b32 v205, v205, v206
    v_lshlrev_b32 v205, 4, v205
    s_lshl_b32 s60, s20, 6
    v_add3_u32 v186, v204, v205, s60
    v_add_u32 v187, 1024, v186
    v_add_u32 v188, 2048, v186
    s_mul_i32 s60, s23, 12288
    s_mul_i32 s61, s24, 3072
    s_add_u32 s29, s60, s61
    s_add_u32 s29, s29, 98304
    v_lshrrev_b32 v204, 3, v255
    s_lshl_b32 s60, s24, 5
    v_add_u32 v204, s60, v204
    v_lshlrev_b32 v204, 1, v204
    s_lshl_b32 s60, s21, 8
    s_add_u32 s60, s60, s23
    v_add_u32 v204, s60, v204
    v_lshlrev_b32 v204, 11, v204
    v_and_b32 v205, 7, v255
    v_lshrrev_b32 v206, 4, v255
    v_xor_b32 v205, v205, v206
    v_xor_b32 v206, 4, v205
    v_lshlrev_b32 v205, 4, v205
    v_lshlrev_b32 v206, 4, v206
    v_add_u32 v182, v204, v205
    v_add_u32 v183, v204, v206
    v_add_u32 v183, 31744, v183
    v_add_u32 v184, v204, v205
    v_add_u32 v184, 63488, v184
    v_add_u32 v185, v204, v206
    v_add_u32 v185, 95232, v185
    s_lshl_b32 s60, s21, 8
    s_lshl_b32 s61, s25, 6
    s_add_u32 s60, s60, s61
    s_lshl_b32 s61, s22, 3
    s_add_u32 s60, s60, s61
    v_add_u32 v204, s60, v255
    v_lshlrev_b32 v189, 11, v204
    v_mov_b32 v205, 0x7fffff00
    v_cmp_gt_u32 vcc, 8, v255
    s_lshl_b32 s60, s21, 3
    s_and_b32 s61, s25, 1
    s_lshl_b32 s61, s61, 2
    s_add_u32 s60, s60, s61
    s_add_u32 s60, s60, s24
    s_mul_i32 s60, s60, 6144
    v_cndmask_b32 v189, v205, v189, vcc
    s_lshr_b32 s61, s20, 1
    s_lshl_b32 s61, s61, 7
    s_add_u32 s60, s60, s61
    v_lshlrev_b32 v204, 11, v255
    v_add_u32 v190, s60, v204
    v_cmp_gt_u32 vcc, 3, v255
    s_mov_b32 s56, 128
    s_mov_b32 s57, 393216
    v_cndmask_b32 v190, v205, v190, vcc
    s_lshl_b32 s28, s22, 12
    s_mov_b32 s30, 0
    s_mov_b32 s31, 0
    s_mov_b32 s52, 0
    s_mov_b32 s53, 0
    s_waitcnt lgkmcnt(0)
    s_mov_b32 s4, s32
    s_mov_b32 s5, s33
    s_mov_b32 s6, 0x400000
    s_mov_b32 s7, 0x20000
    s_cmp_eq_u32 s23, 0
    s_cselect_b32 s8, s34, s40
    s_cselect_b32 s9, s35, s41
    s_mov_b32 s10, 0x600000
    s_mov_b32 s11, 0x20000
    buffer_load_dword v191, v189, s[4:7], s56 offen
    buffer_load_dword v192, v190, s[8:11], s57 offen
    s_add_u32 s56, s56, 128
    s_min_u32 s56, s56, 1920
    s_add_u32 s57, s57, 393216
    s_min_u32 s57, s57, 5898240
    s_add_u32 m0, s29, s53
    s_nop 0
    buffer_load_dwordx4 v186, s[8:11], s31 offen lds
    buffer_load_dwordx4 v187, s[8:11], s31 offen offset:1024 lds
    buffer_load_dwordx4 v188, s[8:11], s31 offen offset:2048 lds
    s_add_u32 s31, s31, 393216
    s_xor_b32 s53, s53, 24576
    s_add_u32 m0, s28, s52
    s_nop 0
    buffer_load_dwordx4 v182, s[4:7], s30 offen lds
    buffer_load_dwordx4 v183, s[4:7], s30 offen offset:1024 lds
    buffer_load_dwordx4 v184, s[4:7], s30 offen offset:2048 lds
    buffer_load_dwordx4 v185, s[4:7], s30 offen offset:3072 lds
    s_add_u32 s30, s30, 128
    s_add_u32 s52, s52, 32768
    s_cmp_eq_u32 s52, 98304
    s_cselect_b32 s52, 0, s52
    s_mov_b32 s12, s50
    s_mov_b32 s13, s51
    s_mov_b32 s14, 0x10000000
    s_mov_b32 s15, 0x20000
    s_mov_b32 s16, s48
    s_mov_b32 s17, s49
    s_mov_b32 s18, 0x100
    s_mov_b32 s19, 0x20000
    s_or_b32 s60, s2, s22
    s_cmp_lg_u32 s60, 0
    s_cbranch_scc1 L_nononce
    s_memrealtime s[60:61]
    s_waitcnt lgkmcnt(0)
    s_or_b32 s60, s60, 1
    v_mov_b32 v204, s60
    buffer_store_dword v204, v253, s[16:19], 0 offen sc1
L_nononce:
    s_lshr_b32 s60, s20, 2
    s_and_b32 s61, s20, 3
    s_lshl_b32 s61, s61, 3
    s_add_u32 s61, s61, s22
    s_lshl_b32 s62, s21, 3
    s_add_u32 s62, s62, s60
    s_lshl_b32 s68, s62, 5
    s_add_u32 s68, s68, s61
    s_lshl_b32 s68, s68, 2
    s_add_u32 s68, s68, 0x1200000
    s_and_b32 s62, s60, 3
    s_lshl_b32 s62, s62, 5
    s_add_u32 s62, s62, s61
    s_lshl_b32 s62, s62, 1
    s_lshr_b32 s63, s60, 2
    s_add_u32 s62, s62, s63
    s_lshl_b32 s63, s21, 8
    s_add_u32 s62, s62, s63
    s_lshl_b32 s62, s62, 11
    s_mov_b32 s64, s44
    s_mov_b32 s65, s45
    s_mov_b32 s66, 2048
    s_mov_b32 s67, 0x20000
    v_lshlrev_b32 v193, 5, v255
    buffer_load_dwordx4 v[212:215], v193, s[4:7], s62 offen offset:0
    buffer_load_dwordx4 v[216:219], v193, s[4:7], s62 offen offset:16
    buffer_load_dwordx4 v[236:239], v193, s[64:67], 0 offen offset:0
    buffer_load_dwordx4 v[240:243], v193, s[64:67], 0 offen offset:16
    v_and_b32 v204, 15, v255
    v_lshrrev_b32 v205, 4, v255
    v_lshrrev_b32 v206, 1, v204
    v_xor_b32 v205, v205, v206
    v_lshlrev_b32 v205, 4, v205
    v_lshlrev_b32 v204, 7, v204
    v_add_u32 v204, v204, v205
    s_lshl_b32 s60, s24, 13
    v_add_u32 v204, s60, v204
    s_lshl_b32 s60, s23, 12
    s_xor_b32 s61, s60, 4096
    v_xor_b32 v205, 64, v204
    v_add_u32 v176, s60, v204
    v_add_u32 v177, s60, v205
    v_add_u32 v178, s61, v204
    v_add_u32 v179, s61, v205
    v_lshrrev_b32 v204, 5, v255
    v_mul_u32_u24 v204, 3072, v204
    v_bfe_u32 v205, v255, 4, 1
    v_mul_u32_u24 v205, 544, v205
    v_bfe_u32 v206, v255, 2, 2
    v_lshlrev_b32 v206, 6, v206
    v_add3_u32 v204, v204, v205, v206
    v_and_b32 v205, 3, v255
    v_lshlrev_b32 v205, 3, v205
    s_mul_i32 s60, s23, 12288
    s_add_u32 s60, s60, 98304
    v_add3_u32 v180, v204, v205, s60
    v_xor_b32 v181, 32, v180
    s_and_b32 s60, s2, 7
    s_lshr_b32 s61, s2, 3
    s_lshr_b32 s62, s60, 1
    s_lshl_b32 s62, s62, 2
    s_and_b32 s63, s61, 3
    s_add_u32 s62, s62, s63
    s_and_b32 s63, s60, 1
    s_lshl_b32 s63, s63, 3
    s_lshr_b32 s64, s61, 2
    s_add_u32 s33, s63, s64
    s_lshl_b32 s32, s62, 2
    s_add_u32 s32, s32, s24
    s_lshl_b32 s63, s32, 6
    s_lshl_b32 s64, s23, 4
    s_add_u32 s63, s63, s64
    s_lshl_b32 s63, s63, 11
    s_add_u32 s35, s63, 0x800000
    s_add_u32 s34, s35, 65536
    s_lshl_b32 s63, s23, 9
    s_lshl_b32 s64, s24, 5
    s_add_u32 s63, s63, s64
    s_lshl_b32 s38, s63, 11
    s_lshl_b32 s63, s23, 14
    s_lshl_b32 s64, s24, 11
    s_add_u32 s39, s63, s64
    s_lshl_b32 s63, s32, 7
    s_add_u32 s48, s63, 0x1200000
    s_lshr_b32 s63, s62, 1
    s_lshl_b32 s63, s63, 13
    s_add_u32 s40, s63, 0x1220000
    s_add_u32 s41, s63, 0x1230000
    s_lshl_b32 s63, s21, 5
    s_add_u32 s63, s63, s20
    s_lshl_b32 s63, s63, 8
    s_add_u32 s44, s63, 0x1220000
    s_add_u32 s45, s63, 0x1230000
    s_lshr_b32 s63, s62, 1
    s_lshl_b32 s63, s63, 8
    s_and_b32 s64, s62, 1
    s_add_u32 s63, s63, s64
    s_lshl_b32 s64, s24, 6
    s_add_u32 s63, s63, s64
    s_lshl_b32 s63, s63, 11
    s_lshl_b32 s64, s33, 7
    s_add_u32 s63, s63, s64
    s_lshl_b32 s64, s23, 6
    s_add_u32 s49, s63, s64
    v_lshrrev_b32 v204, 2, v255
    v_lshlrev_b32 v204, 11, v204
    v_and_b32 v205, 3, v255
    v_lshlrev_b32 v205, 4, v205
    s_lshl_b32 s63, s33, 7
    v_add3_u32 v224, v204, v205, s63
    v_add_u32 v225, 32768, v224
    v_add_u32 v226, 64, v224
    v_add_u32 v227, 32832, v224
    v_lshrrev_b32 v204, 5, v255
    v_lshlrev_b32 v204, 8, v204
    v_bfe_u32 v205, v255, 2, 2
    v_lshlrev_b32 v205, 6, v205
    v_bfe_u32 v206, v255, 4, 1
    v_lshlrev_b32 v206, 5, v206
    v_add3_u32 v204, v204, v205, v206
    v_and_b32 v205, 3, v255
    v_lshlrev_b32 v205, 3, v205
    s_mul_i32 s63, s23, 24576
    v_add3_u32 v228, v204, v205, s63
    v_and_b32 v229, 31, v255
    v_lshlrev_b32 v233, 2, v229
    v_lshlrev_b32 v234, 8, v229
    s_lshr_b32 s50, s61, 2
    s_and_b32 s50, s50, 3
    v_lshlrev_b32 v229, 12, v229
    v_lshrrev_b32 v204, 5, v255
    v_lshlrev_b32 v204, 4, v204
    v_add_u32 v229, v229, v204
    s_and_b32 s63, s61, 15
    s_lshl_b32 s63, s63, 6
    s_lshl_b32 s64, s22, 3
    s_add_u32 s63, s63, s64
    v_lshrrev_b32 v204, 3, v255
    v_add_u32 v204, s63, v204
    v_lshlrev_b32 v204, 11, v204
    v_and_b32 v205, 7, v255
    v_lshlrev_b32 v205, 7, v205
    s_and_b32 s63, s60, 1
    s_lshl_b32 s63, s63, 10
    v_add3_u32 v230, v204, v205, s63
    s_mov_b32 s54, 32768
    s_mov_b32 s55, 24576
    s_mov_b32 s58, 0
    s_mov_b32 s59, 0xffff0000
    s_mov_b32 s71, 32768
    s_waitcnt vmcnt(4)
    s_barrier
    ds_read_b128 v[96:99], v176 offset:0
    ds_read_b64_tr_b16 v[112:113], v180 offset:0
    ds_read_b64_tr_b16 v[114:115], v180 offset:256
    ds_read_b64_tr_b16 v[116:117], v181 offset:0
    ds_read_b64_tr_b16 v[118:119], v181 offset:256
    ds_read_b64_tr_b16 v[120:121], v180 offset:1024
    ds_read_b64_tr_b16 v[122:123], v180 offset:1280
    ds_read_b64_tr_b16 v[124:125], v181 offset:1024
    ds_read_b64_tr_b16 v[126:127], v181 offset:1280
    ds_read_b64_tr_b16 v[128:129], v180 offset:2048
    ds_read_b64_tr_b16 v[130:131], v180 offset:2304
    ds_read_b64_tr_b16 v[132:133], v181 offset:2048
    ds_read_b64_tr_b16 v[134:135], v181 offset:2304
    ds_read_b128 v[100:103], v176 offset:2048
    ds_read_b128 v[104:107], v178 offset:0
    ds_read_b128 v[108:111], v178 offset:2048
    s_waitcnt lgkmcnt(13)
    v_mfma_f32_16x16x32_bf16 v[0:3], v[112:115], v[96:99], 0
    ds_read_b128 v[136:139], v177 offset:0
    s_waitcnt lgkmcnt(12)
    v_mfma_f32_16x16x32_bf16 v[4:7], v[116:119], v[96:99], 0
    ds_read_b64_tr_b16 v[152:153], v180 offset:6144
    s_add_u32 m0, s29, s53
    s_nop 0
    buffer_load_dwordx4 v186, s[8:11], s31 offen lds
    s_waitcnt lgkmcnt(11)
    v_mfma_f32_16x16x32_bf16 v[8:11], v[120:123], v[96:99], 0
    ds_read_b64_tr_b16 v[154:155], v180 offset:6400
    buffer_load_dwordx4 v187, s[8:11], s31 offen offset:1024 lds
    s_waitcnt lgkmcnt(10)
    v_mfma_f32_16x16x32_bf16 v[12:15], v[124:127], v[96:99], 0
    ds_read_b64_tr_b16 v[156:157], v181 offset:6144
    buffer_load_dwordx4 v188, s[8:11], s31 offen offset:2048 lds
    s_add_u32 s31, s31, 393216
    s_xor_b32 s53, s53, 24576
    s_waitcnt lgkmcnt(9)
    v_mfma_f32_16x16x32_bf16 v[16:19], v[96:99], v[128:131], 0
    ds_read_b64_tr_b16 v[158:159], v181 offset:6400
    s_waitcnt lgkmcnt(8)
    v_mfma_f32_16x16x32_bf16 v[20:23], v[96:99], v[132:135], 0
    ds_read_b64_tr_b16 v[160:161], v180 offset:7168
    s_add_u32 m0, s28, s52
    s_nop 0
    buffer_load_dwordx4 v182, s[4:7], s30 offen lds
    s_waitcnt lgkmcnt(8)
    v_mfma_f32_16x16x32_bf16 v[24:27], v[112:115], v[100:103], 0
    ds_read_b64_tr_b16 v[162:163], v180 offset:7424
    buffer_load_dwordx4 v183, s[4:7], s30 offen offset:1024 lds
    v_mfma_f32_16x16x32_bf16 v[28:31], v[116:119], v[100:103], 0
    ds_read_b64_tr_b16 v[164:165], v181 offset:7168
    v_mfma_f32_16x16x32_bf16 v[32:35], v[120:123], v[100:103], 0
    buffer_load_dwordx4 v184, s[4:7], s30 offen offset:2048 lds
    v_mfma_f32_16x16x32_bf16 v[36:39], v[124:127], v[100:103], 0
    ds_read_b64_tr_b16 v[166:167], v181 offset:7424
    buffer_load_dwordx4 v185, s[4:7], s30 offen offset:3072 lds
    s_add_u32 s30, s30, 128
    s_add_u32 s52, s52, 32768
    s_cmp_eq_u32 s52, 98304
    s_cselect_b32 s52, 0, s52
    v_mfma_f32_16x16x32_bf16 v[40:43], v[100:103], v[128:131], 0
    ds_read_b64_tr_b16 v[168:169], v180 offset:8192
    v_mfma_f32_16x16x32_bf16 v[44:47], v[100:103], v[132:135], 0
    ds_read_b64_tr_b16 v[170:171], v180 offset:8448
    s_add_u32 m0, s28, s52
    s_nop 0
    buffer_load_dwordx4 v182, s[4:7], s30 offen lds
    s_waitcnt lgkmcnt(12)
    v_mfma_f32_16x16x32_bf16 v[48:51], v[112:115], v[104:107], 0
    ds_read_b64_tr_b16 v[172:173], v181 offset:8192
    buffer_load_dwordx4 v183, s[4:7], s30 offen offset:1024 lds
    v_mfma_f32_16x16x32_bf16 v[52:55], v[116:119], v[104:107], 0
    ds_read_b64_tr_b16 v[174:175], v181 offset:8448
    v_mfma_f32_16x16x32_bf16 v[56:59], v[120:123], v[104:107], 0
    ds_read_b128 v[140:143], v177 offset:2048
    buffer_load_dwordx4 v184, s[4:7], s30 offen offset:2048 lds
    v_mfma_f32_16x16x32_bf16 v[60:63], v[124:127], v[104:107], 0
    ds_read_b128 v[144:147], v179 offset:0
    buffer_load_dwordx4 v185, s[4:7], s30 offen offset:3072 lds
    s_add_u32 s30, s30, 128
    s_add_u32 s52, s52, 32768
    s_cmp_eq_u32 s52, 98304
    s_cselect_b32 s52, 0, s52
    v_mfma_f32_16x16x32_bf16 v[64:67], v[104:107], v[128:131], 0
    ds_read_b128 v[148:151], v179 offset:2048
    v_mfma_f32_16x16x32_bf16 v[68:71], v[104:107], v[132:135], 0
    buffer_load_dword v191, v189, s[4:7], s56 offen
    s_waitcnt lgkmcnt(15)
    v_mfma_f32_16x16x32_bf16 v[72:75], v[112:115], v[108:111], 0
    buffer_load_dword v192, v190, s[8:11], s57 offen
    s_add_u32 s56, s56, 128
    s_min_u32 s56, s56, 1920
    s_add_u32 s57, s57, 393216
    s_min_u32 s57, s57, 5898240
    v_mfma_f32_16x16x32_bf16 v[76:79], v[116:119], v[108:111], 0
    v_mfma_f32_16x16x32_bf16 v[80:83], v[120:123], v[108:111], 0
    buffer_load_dword v191, v189, s[4:7], s56 offen
    v_add_u32 v176, s54, v176
    v_add_u32 v177, s54, v177
    v_mfma_f32_16x16x32_bf16 v[84:87], v[124:127], v[108:111], 0
    buffer_load_dword v192, v190, s[8:11], s57 offen
    s_add_u32 s56, s56, 128
    s_min_u32 s56, s56, 1920
    s_add_u32 s57, s57, 393216
    s_min_u32 s57, s57, 5898240
    v_add_u32 v178, s54, v178
    v_mfma_f32_16x16x32_bf16 v[88:91], v[108:111], v[128:131], 0
    v_add_u32 v179, s54, v179
    v_add_u32 v180, s55, v180
    v_mfma_f32_16x16x32_bf16 v[92:95], v[108:111], v[132:135], 0
    v_add_u32 v181, s55, v181
    s_waitcnt lgkmcnt(13)
    v_mfma_f32_16x16x32_bf16 v[0:3], v[152:155], v[136:139], v[0:3]
    s_waitcnt lgkmcnt(11)
    v_mfma_f32_16x16x32_bf16 v[4:7], v[156:159], v[136:139], v[4:7]
    s_waitcnt lgkmcnt(9)
    v_mfma_f32_16x16x32_bf16 v[8:11], v[160:163], v[136:139], v[8:11]
    s_waitcnt lgkmcnt(7)
    v_mfma_f32_16x16x32_bf16 v[12:15], v[164:167], v[136:139], v[12:15]
    s_waitcnt vmcnt(8) lgkmcnt(0)
    s_barrier
    v_mfma_f32_16x16x32_bf16 v[16:19], v[136:139], v[168:171], v[16:19]
    ds_read_b128 v[96:99], v176 offset:0
    s_add_u32 m0, s29, s53
    s_nop 0
    buffer_load_dwordx4 v186, s[8:11], s31 offen lds
    v_mfma_f32_16x16x32_bf16 v[20:23], v[136:139], v[172:175], v[20:23]
    ds_read_b64_tr_b16 v[112:113], v180 offset:0
    v_mfma_f32_16x16x32_bf16 v[24:27], v[152:155], v[140:143], v[24:27]
    ds_read_b64_tr_b16 v[114:115], v180 offset:256
    v_mfma_f32_16x16x32_bf16 v[28:31], v[156:159], v[140:143], v[28:31]
    ds_read_b64_tr_b16 v[116:117], v181 offset:0
    buffer_load_dwordx4 v187, s[8:11], s31 offen offset:1024 lds
    v_mfma_f32_16x16x32_bf16 v[32:35], v[160:163], v[140:143], v[32:35]
    ds_read_b64_tr_b16 v[118:119], v181 offset:256
    v_mfma_f32_16x16x32_bf16 v[36:39], v[164:167], v[140:143], v[36:39]
    ds_read_b64_tr_b16 v[120:121], v180 offset:1024
    v_mfma_f32_16x16x32_bf16 v[40:43], v[140:143], v[168:171], v[40:43]
    ds_read_b64_tr_b16 v[122:123], v180 offset:1280
    buffer_load_dwordx4 v188, s[8:11], s31 offen offset:2048 lds
    s_add_u32 s31, s31, 393216
    s_xor_b32 s53, s53, 24576
    v_mfma_f32_16x16x32_bf16 v[44:47], v[140:143], v[172:175], v[44:47]
    ds_read_b64_tr_b16 v[124:125], v181 offset:1024
    v_mfma_f32_16x16x32_bf16 v[48:51], v[152:155], v[144:147], v[48:51]
    v_mfma_f32_16x16x32_bf16 v[52:55], v[156:159], v[144:147], v[52:55]
    ds_read_b64_tr_b16 v[126:127], v181 offset:1280
    v_mfma_f32_16x16x32_bf16 v[56:59], v[160:163], v[144:147], v[56:59]
    ds_read_b64_tr_b16 v[128:129], v180 offset:2048
    v_mfma_f32_16x16x32_bf16 v[60:63], v[164:167], v[144:147], v[60:63]
    ds_read_b64_tr_b16 v[130:131], v180 offset:2304
    v_mfma_f32_16x16x32_bf16 v[64:67], v[144:147], v[168:171], v[64:67]
    ds_read_b64_tr_b16 v[132:133], v181 offset:2048
    v_mfma_f32_16x16x32_bf16 v[68:71], v[144:147], v[172:175], v[68:71]
    ds_read_b64_tr_b16 v[134:135], v181 offset:2304
    v_mfma_f32_16x16x32_bf16 v[72:75], v[152:155], v[148:151], v[72:75]
    ds_read_b128 v[100:103], v176 offset:2048
    v_mfma_f32_16x16x32_bf16 v[76:79], v[156:159], v[148:151], v[76:79]
    ds_read_b128 v[104:107], v178 offset:0
    v_mfma_f32_16x16x32_bf16 v[80:83], v[160:163], v[148:151], v[80:83]
    ds_read_b128 v[108:111], v178 offset:2048
    v_mfma_f32_16x16x32_bf16 v[84:87], v[164:167], v[148:151], v[84:87]
    v_mfma_f32_16x16x32_bf16 v[88:91], v[148:151], v[168:171], v[88:91]
    v_mfma_f32_16x16x32_bf16 v[92:95], v[148:151], v[172:175], v[92:95]
    v_mov_b32 v204, 0
    v_dot2_f32_bf16 v204, v212, v236, v204
    v_dot2_f32_bf16 v204, v213, v237, v204
    v_dot2_f32_bf16 v204, v214, v238, v204
    v_dot2_f32_bf16 v204, v215, v239, v204
    v_dot2_f32_bf16 v204, v216, v240, v204
    v_dot2_f32_bf16 v204, v217, v241, v204
    v_dot2_f32_bf16 v204, v218, v242, v204
    v_dot2_f32_bf16 v204, v219, v243, v204
    s_nop 2
    s_nop 1
    v_add_f32_dpp v204, v204, v204 row_shr:1 row_mask:0xf bank_mask:0xf bound_ctrl:0
    s_nop 1
    v_add_f32_dpp v204, v204, v204 row_shr:2 row_mask:0xf bank_mask:0xf bound_ctrl:0
    s_nop 1
    v_add_f32_dpp v204, v204, v204 row_shr:4 row_mask:0xf bank_mask:0xf bound_ctrl:0
    s_nop 1
    v_add_f32_dpp v204, v204, v204 row_shr:8 row_mask:0xf bank_mask:0xf bound_ctrl:0
    s_nop 1
    v_readlane_b32 s60, v204, 15
    v_readlane_b32 s61, v204, 31
    v_readlane_b32 s62, v204, 47
    v_readlane_b32 s63, v204, 63
    s_nop 1
    v_mov_b32 v204, s60
    v_add_f32 v204, s61, v204
    v_add_f32 v204, s62, v204
    v_add_f32 v204, s63, v204
    v_mul_f32 v204, 0xbfb8aa3b, v204
    v_exp_f32 v204, v204
    s_nop 0
    v_add_f32 v204, 1.0, v204
    v_rcp_f32 v204, v204
    s_nop 0
    s_add_u32 s58, s58, 1
    s_cmp_eq_u32 s58, 3
    s_cselect_b32 s58, 0, s58
    s_cmp_eq_u32 s58, 2
    s_cselect_b32 s54, s59, s71
    s_sub_u32 s55, 0, s55
    s_mov_b32 s27, 13
L_g1_loop:
    s_waitcnt lgkmcnt(13)
    v_mfma_f32_16x16x32_bf16 v[0:3], v[112:115], v[96:99], v[0:3]
    ds_read_b128 v[136:139], v177 offset:0
    s_waitcnt lgkmcnt(12)
    v_mfma_f32_16x16x32_bf16 v[4:7], v[116:119], v[96:99], v[4:7]
    ds_read_b64_tr_b16 v[152:153], v180 offset:6144
    s_waitcnt lgkmcnt(11)
    v_mfma_f32_16x16x32_bf16 v[8:11], v[120:123], v[96:99], v[8:11]
    ds_read_b64_tr_b16 v[154:155], v180 offset:6400
    s_waitcnt lgkmcnt(10)
    v_mfma_f32_16x16x32_bf16 v[12:15], v[124:127], v[96:99], v[12:15]
    ds_read_b64_tr_b16 v[156:157], v181 offset:6144
    s_add_u32 m0, s28, s52
    s_nop 0
    buffer_load_dwordx4 v182, s[4:7], s30 offen lds
    s_waitcnt lgkmcnt(9)
    v_mfma_f32_16x16x32_bf16 v[16:19], v[96:99], v[128:131], v[16:19]
    ds_read_b64_tr_b16 v[158:159], v181 offset:6400
    s_waitcnt lgkmcnt(8)
    v_mfma_f32_16x16x32_bf16 v[20:23], v[96:99], v[132:135], v[20:23]
    ds_read_b64_tr_b16 v[160:161], v180 offset:7168
    s_waitcnt lgkmcnt(8)
    v_mfma_f32_16x16x32_bf16 v[24:27], v[112:115], v[100:103], v[24:27]
    ds_read_b64_tr_b16 v[162:163], v180 offset:7424
    v_mfma_f32_16x16x32_bf16 v[28:31], v[116:119], v[100:103], v[28:31]
    ds_read_b64_tr_b16 v[164:165], v181 offset:7168
    buffer_load_dwordx4 v183, s[4:7], s30 offen offset:1024 lds
    v_mfma_f32_16x16x32_bf16 v[32:35], v[120:123], v[100:103], v[32:35]
    v_mfma_f32_16x16x32_bf16 v[36:39], v[124:127], v[100:103], v[36:39]
    ds_read_b64_tr_b16 v[166:167], v181 offset:7424
    v_mfma_f32_16x16x32_bf16 v[40:43], v[100:103], v[128:131], v[40:43]
    ds_read_b64_tr_b16 v[168:169], v180 offset:8192
    v_mfma_f32_16x16x32_bf16 v[44:47], v[100:103], v[132:135], v[44:47]
    ds_read_b64_tr_b16 v[170:171], v180 offset:8448
    buffer_load_dwordx4 v184, s[4:7], s30 offen offset:2048 lds
    s_waitcnt lgkmcnt(12)
    v_mfma_f32_16x16x32_bf16 v[48:51], v[112:115], v[104:107], v[48:51]
    ds_read_b64_tr_b16 v[172:173], v181 offset:8192
    v_mfma_f32_16x16x32_bf16 v[52:55], v[116:119], v[104:107], v[52:55]
    ds_read_b64_tr_b16 v[174:175], v181 offset:8448
    v_mfma_f32_16x16x32_bf16 v[56:59], v[120:123], v[104:107], v[56:59]
    ds_read_b128 v[140:143], v177 offset:2048
    v_mfma_f32_16x16x32_bf16 v[60:63], v[124:127], v[104:107], v[60:63]
    ds_read_b128 v[144:147], v179 offset:0
    buffer_load_dwordx4 v185, s[4:7], s30 offen offset:3072 lds
    s_add_u32 s30, s30, 128
    s_add_u32 s52, s52, 32768
    s_cmp_eq_u32 s52, 98304
    s_cselect_b32 s52, 0, s52
    v_mfma_f32_16x16x32_bf16 v[64:67], v[104:107], v[128:131], v[64:67]
    ds_read_b128 v[148:151], v179 offset:2048
    v_mfma_f32_16x16x32_bf16 v[68:71], v[104:107], v[132:135], v[68:71]
    s_waitcnt lgkmcnt(15)
    v_mfma_f32_16x16x32_bf16 v[72:75], v[112:115], v[108:111], v[72:75]
    buffer_load_dword v191, v189, s[4:7], s56 offen
    v_mfma_f32_16x16x32_bf16 v[76:79], v[116:119], v[108:111], v[76:79]
    v_mfma_f32_16x16x32_bf16 v[80:83], v[120:123], v[108:111], v[80:83]
    v_add_u32 v176, s54, v176
    v_add_u32 v177, s54, v177
    v_mfma_f32_16x16x32_bf16 v[84:87], v[124:127], v[108:111], v[84:87]
    buffer_load_dword v192, v190, s[8:11], s57 offen
    s_add_u32 s56, s56, 128
    s_min_u32 s56, s56, 1920
    s_add_u32 s57, s57, 393216
    s_min_u32 s57, s57, 5898240
    v_add_u32 v178, s54, v178
    v_mfma_f32_16x16x32_bf16 v[88:91], v[108:111], v[128:131], v[88:91]
    v_add_u32 v179, s54, v179
    v_add_u32 v180, s55, v180
    v_mfma_f32_16x16x32_bf16 v[92:95], v[108:111], v[132:135], v[92:95]
    v_add_u32 v181, s55, v181
    s_waitcnt lgkmcnt(13)
    v_mfma_f32_16x16x32_bf16 v[0:3], v[152:155], v[136:139], v[0:3]
    s_waitcnt lgkmcnt(11)
    v_mfma_f32_16x16x32_bf16 v[4:7], v[156:159], v[136:139], v[4:7]
    s_waitcnt lgkmcnt(9)
    v_mfma_f32_16x16x32_bf16 v[8:11], v[160:163], v[136:139], v[8:11]
    s_waitcnt lgkmcnt(7)
    v_mfma_f32_16x16x32_bf16 v[12:15], v[164:167], v[136:139], v[12:15]
    s_waitcnt vmcnt(6) lgkmcnt(0)
    s_barrier
    v_mfma_f32_16x16x32_bf16 v[16:19], v[136:139], v[168:171], v[16:19]
    ds_read_b128 v[96:99], v176 offset:0
    s_add_u32 m0, s29, s53
    s_nop 0
    buffer_load_dwordx4 v186, s[8:11], s31 offen lds
    v_mfma_f32_16x16x32_bf16 v[20:23], v[136:139], v[172:175], v[20:23]
    ds_read_b64_tr_b16 v[112:113], v180 offset:0
    v_mfma_f32_16x16x32_bf16 v[24:27], v[152:155], v[140:143], v[24:27]
    ds_read_b64_tr_b16 v[114:115], v180 offset:256
    v_mfma_f32_16x16x32_bf16 v[28:31], v[156:159], v[140:143], v[28:31]
    ds_read_b64_tr_b16 v[116:117], v181 offset:0
    buffer_load_dwordx4 v187, s[8:11], s31 offen offset:1024 lds
    v_mfma_f32_16x16x32_bf16 v[32:35], v[160:163], v[140:143], v[32:35]
    ds_read_b64_tr_b16 v[118:119], v181 offset:256
    v_mfma_f32_16x16x32_bf16 v[36:39], v[164:167], v[140:143], v[36:39]
    ds_read_b64_tr_b16 v[120:121], v180 offset:1024
    v_mfma_f32_16x16x32_bf16 v[40:43], v[140:143], v[168:171], v[40:43]
    ds_read_b64_tr_b16 v[122:123], v180 offset:1280
    buffer_load_dwordx4 v188, s[8:11], s31 offen offset:2048 lds
    s_add_u32 s31, s31, 393216
    s_xor_b32 s53, s53, 24576
    v_mfma_f32_16x16x32_bf16 v[44:47], v[140:143], v[172:175], v[44:47]
    ds_read_b64_tr_b16 v[124:125], v181 offset:1024
    v_mfma_f32_16x16x32_bf16 v[48:51], v[152:155], v[144:147], v[48:51]
    v_mfma_f32_16x16x32_bf16 v[52:55], v[156:159], v[144:147], v[52:55]
    ds_read_b64_tr_b16 v[126:127], v181 offset:1280
    v_mfma_f32_16x16x32_bf16 v[56:59], v[160:163], v[144:147], v[56:59]
    ds_read_b64_tr_b16 v[128:129], v180 offset:2048
    v_mfma_f32_16x16x32_bf16 v[60:63], v[164:167], v[144:147], v[60:63]
    ds_read_b64_tr_b16 v[130:131], v180 offset:2304
    v_mfma_f32_16x16x32_bf16 v[64:67], v[144:147], v[168:171], v[64:67]
    ds_read_b64_tr_b16 v[132:133], v181 offset:2048
    v_mfma_f32_16x16x32_bf16 v[68:71], v[144:147], v[172:175], v[68:71]
    ds_read_b64_tr_b16 v[134:135], v181 offset:2304
    v_mfma_f32_16x16x32_bf16 v[72:75], v[152:155], v[148:151], v[72:75]
    ds_read_b128 v[100:103], v176 offset:2048
    v_mfma_f32_16x16x32_bf16 v[76:79], v[156:159], v[148:151], v[76:79]
    ds_read_b128 v[104:107], v178 offset:0
    v_mfma_f32_16x16x32_bf16 v[80:83], v[160:163], v[148:151], v[80:83]
    ds_read_b128 v[108:111], v178 offset:2048
    v_mfma_f32_16x16x32_bf16 v[84:87], v[164:167], v[148:151], v[84:87]
    v_mfma_f32_16x16x32_bf16 v[88:91], v[148:151], v[168:171], v[88:91]
    v_mfma_f32_16x16x32_bf16 v[92:95], v[148:151], v[172:175], v[92:95]
    s_add_u32 s58, s58, 1
    s_cmp_eq_u32 s58, 3
    s_cselect_b32 s58, 0, s58
    s_cmp_eq_u32 s58, 2
    s_cselect_b32 s54, s59, s71
    s_sub_u32 s55, 0, s55
    s_sub_u32 s27, s27, 1
    s_cmp_lg_u32 s27, 0
    s_cbranch_scc1 L_g1_loop
    s_waitcnt lgkmcnt(13)
    v_mfma_f32_16x16x32_bf16 v[0:3], v[112:115], v[96:99], v[0:3]
    ds_read_b128 v[136:139], v177 offset:0
    s_waitcnt lgkmcnt(12)
    v_mfma_f32_16x16x32_bf16 v[4:7], v[116:119], v[96:99], v[4:7]
    ds_read_b64_tr_b16 v[152:153], v180 offset:6144
    s_waitcnt lgkmcnt(11)
    v_mfma_f32_16x16x32_bf16 v[8:11], v[120:123], v[96:99], v[8:11]
    ds_read_b64_tr_b16 v[154:155], v180 offset:6400
    v_and_b32 v193, 31, v255
    s_waitcnt lgkmcnt(10)
    v_mfma_f32_16x16x32_bf16 v[12:15], v[124:127], v[96:99], v[12:15]
    ds_read_b64_tr_b16 v[156:157], v181 offset:6144
    v_lshrrev_b32 v194, 5, v255
    s_waitcnt lgkmcnt(9)
    v_mfma_f32_16x16x32_bf16 v[16:19], v[96:99], v[128:131], v[16:19]
    ds_read_b64_tr_b16 v[158:159], v181 offset:6400
    v_lshlrev_b32 v194, 2, v194
    s_waitcnt lgkmcnt(8)
    v_mfma_f32_16x16x32_bf16 v[20:23], v[96:99], v[132:135], v[20:23]
    ds_read_b64_tr_b16 v[160:161], v180 offset:7168
    v_sub_u32 v193, v193, v194
    s_waitcnt lgkmcnt(8)
    v_mfma_f32_16x16x32_bf16 v[24:27], v[112:115], v[100:103], v[24:27]
    ds_read_b64_tr_b16 v[162:163], v180 offset:7424
    v_mov_b32 v194, 0xff800000
    v_mfma_f32_16x16x32_bf16 v[28:31], v[116:119], v[100:103], v[28:31]
    ds_read_b64_tr_b16 v[164:165], v181 offset:7168
    s_lshl_b32 s62, s24, 1
    v_mfma_f32_16x16x32_bf16 v[32:35], v[120:123], v[100:103], v[32:35]
    s_add_u32 s62, s62, s23
    v_mfma_f32_16x16x32_bf16 v[36:39], v[124:127], v[100:103], v[36:39]
    ds_read_b64_tr_b16 v[166:167], v181 offset:7424
    s_and_b32 s62, s62, 3
    v_mfma_f32_16x16x32_bf16 v[40:43], v[100:103], v[128:131], v[40:43]
    ds_read_b64_tr_b16 v[168:169], v180 offset:8192
    s_or_b32 s62, s62, s21
    v_mfma_f32_16x16x32_bf16 v[44:47], v[100:103], v[132:135], v[44:47]
    ds_read_b64_tr_b16 v[170:171], v180 offset:8448
    s_cmp_eq_u32 s62, 0
    s_waitcnt lgkmcnt(12)
    v_mfma_f32_16x16x32_bf16 v[48:51], v[112:115], v[104:107], v[48:51]
    ds_read_b64_tr_b16 v[172:173], v181 offset:8192
    s_cselect_b32 s62, 1024, 0
    v_mfma_f32_16x16x32_bf16 v[52:55], v[116:119], v[104:107], v[52:55]
    ds_read_b64_tr_b16 v[174:175], v181 offset:8448
    v_add_u32 v195, s62, v193
    v_mfma_f32_16x16x32_bf16 v[56:59], v[120:123], v[104:107], v[56:59]
    ds_read_b128 v[140:143], v177 offset:2048
    v_subrev_u32 v236, 0, v193
    v_mfma_f32_16x16x32_bf16 v[60:63], v[124:127], v[104:107], v[60:63]
    ds_read_b128 v[144:147], v179 offset:0
    v_subrev_u32 v237, 1, v193
    v_mfma_f32_16x16x32_bf16 v[64:67], v[104:107], v[128:131], v[64:67]
    ds_read_b128 v[148:151], v179 offset:2048
    v_subrev_u32 v238, 2, v193
    v_mfma_f32_16x16x32_bf16 v[68:71], v[104:107], v[132:135], v[68:71]
    v_cmp_le_u32_e64 s[62:63], 8, v236
    s_waitcnt lgkmcnt(15)
    v_mfma_f32_16x16x32_bf16 v[72:75], v[112:115], v[108:111], v[72:75]
    v_cmp_le_u32_e64 s[64:65], 8, v237
    v_mfma_f32_16x16x32_bf16 v[76:79], v[116:119], v[108:111], v[76:79]
    v_cmp_le_u32_e64 s[66:67], 8, v238
    v_mfma_f32_16x16x32_bf16 v[80:83], v[120:123], v[108:111], v[80:83]
    v_add_u32 v176, s54, v176
    v_add_u32 v177, s54, v177
    s_nop 1
    v_mfma_f32_16x16x32_bf16 v[84:87], v[124:127], v[108:111], v[84:87]
    v_add_u32 v178, s54, v178
    v_cndmask_b32_e64 v236, 0, v194, s[62:63]
    v_mfma_f32_16x16x32_bf16 v[88:91], v[108:111], v[128:131], v[88:91]
    v_add_u32 v179, s54, v179
    v_add_u32 v180, s55, v180
    v_cndmask_b32_e64 v237, 0, v194, s[64:65]
    v_mfma_f32_16x16x32_bf16 v[92:95], v[108:111], v[132:135], v[92:95]
    v_add_u32 v181, s55, v181
    s_waitcnt lgkmcnt(13)
    v_mfma_f32_16x16x32_bf16 v[0:3], v[152:155], v[136:139], v[0:3]
    s_waitcnt lgkmcnt(11)
    v_mfma_f32_16x16x32_bf16 v[4:7], v[156:159], v[136:139], v[4:7]
    s_waitcnt lgkmcnt(9)
    v_mfma_f32_16x16x32_bf16 v[8:11], v[160:163], v[136:139], v[8:11]
    v_cndmask_b32_e64 v238, 0, v194, s[66:67]
    s_waitcnt lgkmcnt(7)
    v_mfma_f32_16x16x32_bf16 v[12:15], v[164:167], v[136:139], v[12:15]
    s_waitcnt vmcnt(0) lgkmcnt(0)
    s_barrier
    v_subrev_u32 v239, 3, v193
    v_mfma_f32_16x16x32_bf16 v[16:19], v[136:139], v[168:171], v[16:19]
    ds_read_b128 v[96:99], v176 offset:0
    v_subrev_u32 v240, 8, v193
    v_mfma_f32_16x16x32_bf16 v[20:23], v[136:139], v[172:175], v[20:23]
    ds_read_b64_tr_b16 v[112:113], v180 offset:0
    buffer_store_dword v204, v253, s[12:15], s68 offen sc1
    v_subrev_u32 v241, 9, v193
    v_mfma_f32_16x16x32_bf16 v[24:27], v[152:155], v[140:143], v[24:27]
    ds_read_b64_tr_b16 v[114:115], v180 offset:256
    v_cmp_le_u32_e64 s[62:63], 8, v239
    v_mfma_f32_16x16x32_bf16 v[28:31], v[156:159], v[140:143], v[28:31]
    ds_read_b64_tr_b16 v[116:117], v181 offset:0
    v_cmp_le_u32_e64 s[64:65], 8, v240
    v_mfma_f32_16x16x32_bf16 v[32:35], v[160:163], v[140:143], v[32:35]
    ds_read_b64_tr_b16 v[118:119], v181 offset:256
    buffer_load_dword v191, v253, s[16:19], 0 offen sc1
    v_cmp_le_u32_e64 s[66:67], 8, v241
    v_mfma_f32_16x16x32_bf16 v[36:39], v[164:167], v[140:143], v[36:39]
    ds_read_b64_tr_b16 v[120:121], v180 offset:1024
    s_nop 1
    v_mfma_f32_16x16x32_bf16 v[40:43], v[140:143], v[168:171], v[40:43]
    ds_read_b64_tr_b16 v[122:123], v180 offset:1280
    v_cndmask_b32_e64 v239, 0, v194, s[62:63]
    v_mfma_f32_16x16x32_bf16 v[44:47], v[140:143], v[172:175], v[44:47]
    ds_read_b64_tr_b16 v[124:125], v181 offset:1024
    v_cndmask_b32_e64 v240, 0, v194, s[64:65]
    v_mfma_f32_16x16x32_bf16 v[48:51], v[152:155], v[144:147], v[48:51]
    v_cndmask_b32_e64 v241, 0, v194, s[66:67]
    v_mfma_f32_16x16x32_bf16 v[52:55], v[156:159], v[144:147], v[52:55]
    ds_read_b64_tr_b16 v[126:127], v181 offset:1280
    v_subrev_u32 v242, 10, v193
    v_mfma_f32_16x16x32_bf16 v[56:59], v[160:163], v[144:147], v[56:59]
    ds_read_b64_tr_b16 v[128:129], v180 offset:2048
    v_subrev_u32 v243, 11, v193
    v_mfma_f32_16x16x32_bf16 v[60:63], v[164:167], v[144:147], v[60:63]
    ds_read_b64_tr_b16 v[130:131], v180 offset:2304
    v_subrev_u32 v244, 16, v193
    v_mfma_f32_16x16x32_bf16 v[64:67], v[144:147], v[168:171], v[64:67]
    ds_read_b64_tr_b16 v[132:133], v181 offset:2048
    v_cmp_le_u32_e64 s[62:63], 8, v242
    v_mfma_f32_16x16x32_bf16 v[68:71], v[144:147], v[172:175], v[68:71]
    ds_read_b64_tr_b16 v[134:135], v181 offset:2304
    v_cmp_le_u32_e64 s[64:65], 8, v243
    v_mfma_f32_16x16x32_bf16 v[72:75], v[152:155], v[148:151], v[72:75]
    ds_read_b128 v[100:103], v176 offset:2048
    v_cmp_le_u32_e64 s[66:67], 8, v244
    v_mfma_f32_16x16x32_bf16 v[76:79], v[156:159], v[148:151], v[76:79]
    ds_read_b128 v[104:107], v178 offset:0
    s_nop 1
    v_mfma_f32_16x16x32_bf16 v[80:83], v[160:163], v[148:151], v[80:83]
    ds_read_b128 v[108:111], v178 offset:2048
    v_cndmask_b32_e64 v242, 0, v194, s[62:63]
    v_mfma_f32_16x16x32_bf16 v[84:87], v[164:167], v[148:151], v[84:87]
    v_cndmask_b32_e64 v243, 0, v194, s[64:65]
    v_mfma_f32_16x16x32_bf16 v[88:91], v[148:151], v[168:171], v[88:91]
    v_cndmask_b32_e64 v244, 0, v194, s[66:67]
    v_mfma_f32_16x16x32_bf16 v[92:95], v[148:151], v[172:175], v[92:95]
    s_waitcnt lgkmcnt(13)
    v_mfma_f32_16x16x32_bf16 v[0:3], v[112:115], v[96:99], v[0:3]
    ds_read_b128 v[136:139], v177 offset:0
    s_waitcnt lgkmcnt(12)
    v_mfma_f32_16x16x32_bf16 v[4:7], v[116:119], v[96:99], v[4:7]
    ds_read_b64_tr_b16 v[152:153], v180 offset:6144
    s_waitcnt lgkmcnt(11)
    v_mfma_f32_16x16x32_bf16 v[8:11], v[120:123], v[96:99], v[8:11]
    ds_read_b64_tr_b16 v[154:155], v180 offset:6400
    v_subrev_u32 v245, 17, v193
    s_waitcnt lgkmcnt(10)
    v_mfma_f32_16x16x32_bf16 v[12:15], v[124:127], v[96:99], v[12:15]
    ds_read_b64_tr_b16 v[156:157], v181 offset:6144
    v_subrev_u32 v246, 18, v193
    s_waitcnt lgkmcnt(9)
    v_mfma_f32_16x16x32_bf16 v[16:19], v[96:99], v[128:131], v[16:19]
    ds_read_b64_tr_b16 v[158:159], v181 offset:6400
    v_subrev_u32 v247, 19, v193
    s_waitcnt lgkmcnt(8)
    v_mfma_f32_16x16x32_bf16 v[20:23], v[96:99], v[132:135], v[20:23]
    ds_read_b64_tr_b16 v[160:161], v180 offset:7168
    v_cmp_le_u32_e64 s[62:63], 8, v245
    s_waitcnt lgkmcnt(8)
    v_mfma_f32_16x16x32_bf16 v[24:27], v[112:115], v[100:103], v[24:27]
    ds_read_b64_tr_b16 v[162:163], v180 offset:7424
    v_cmp_le_u32_e64 s[64:65], 8, v246
    v_mfma_f32_16x16x32_bf16 v[28:31], v[116:119], v[100:103], v[28:31]
    ds_read_b64_tr_b16 v[164:165], v181 offset:7168
    v_cmp_le_u32_e64 s[66:67], 8, v247
    v_mfma_f32_16x16x32_bf16 v[32:35], v[120:123], v[100:103], v[32:35]
    s_nop 1
    v_mfma_f32_16x16x32_bf16 v[36:39], v[124:127], v[100:103], v[36:39]
    ds_read_b64_tr_b16 v[166:167], v181 offset:7424
    v_cndmask_b32_e64 v245, 0, v194, s[62:63]
    v_mfma_f32_16x16x32_bf16 v[40:43], v[100:103], v[128:131], v[40:43]
    ds_read_b64_tr_b16 v[168:169], v180 offset:8192
    v_cndmask_b32_e64 v246, 0, v194, s[64:65]
    v_mfma_f32_16x16x32_bf16 v[44:47], v[100:103], v[132:135], v[44:47]
    ds_read_b64_tr_b16 v[170:171], v180 offset:8448
    v_cndmask_b32_e64 v247, 0, v194, s[66:67]
    s_waitcnt lgkmcnt(12)
    v_mfma_f32_16x16x32_bf16 v[48:51], v[112:115], v[104:107], v[48:51]
    ds_read_b64_tr_b16 v[172:173], v181 offset:8192
    v_subrev_u32 v248, 24, v193
    v_mfma_f32_16x16x32_bf16 v[52:55], v[116:119], v[104:107], v[52:55]
    ds_read_b64_tr_b16 v[174:175], v181 offset:8448
    v_subrev_u32 v249, 25, v193
    v_mfma_f32_16x16x32_bf16 v[56:59], v[120:123], v[104:107], v[56:59]
    ds_read_b128 v[140:143], v177 offset:2048
    v_subrev_u32 v250, 26, v193
    v_mfma_f32_16x16x32_bf16 v[60:63], v[124:127], v[104:107], v[60:63]
    ds_read_b128 v[144:147], v179 offset:0
    v_cmp_le_u32_e64 s[62:63], 8, v248
    v_mfma_f32_16x16x32_bf16 v[64:67], v[104:107], v[128:131], v[64:67]
    ds_read_b128 v[148:151], v179 offset:2048
    v_cmp_le_u32_e64 s[64:65], 8, v249
    v_mfma_f32_16x16x32_bf16 v[68:71], v[104:107], v[132:135], v[68:71]
    v_cmp_le_u32_e64 s[66:67], 8, v250
    s_waitcnt lgkmcnt(15)
    v_mfma_f32_16x16x32_bf16 v[72:75], v[112:115], v[108:111], v[72:75]
    s_nop 1
    v_mfma_f32_16x16x32_bf16 v[76:79], v[116:119], v[108:111], v[76:79]
    v_cndmask_b32_e64 v248, 0, v194, s[62:63]
    v_mfma_f32_16x16x32_bf16 v[80:83], v[120:123], v[108:111], v[80:83]
    v_cndmask_b32_e64 v249, 0, v194, s[64:65]
    v_mfma_f32_16x16x32_bf16 v[84:87], v[124:127], v[108:111], v[84:87]
    v_cndmask_b32_e64 v250, 0, v194, s[66:67]
    v_mfma_f32_16x16x32_bf16 v[88:91], v[108:111], v[128:131], v[88:91]
    v_subrev_u32 v251, 27, v193
    v_mfma_f32_16x16x32_bf16 v[92:95], v[108:111], v[132:135], v[92:95]
    s_waitcnt lgkmcnt(13)
    v_mfma_f32_16x16x32_bf16 v[0:3], v[152:155], v[136:139], v[0:3]
    s_waitcnt lgkmcnt(11)
    v_mfma_f32_16x16x32_bf16 v[4:7], v[156:159], v[136:139], v[4:7]
    s_waitcnt lgkmcnt(9)
    v_mfma_f32_16x16x32_bf16 v[8:11], v[160:163], v[136:139], v[8:11]
    v_cmp_le_u32_e64 s[62:63], 8, v251
    s_waitcnt lgkmcnt(7)
    v_mfma_f32_16x16x32_bf16 v[12:15], v[164:167], v[136:139], v[12:15]
    s_waitcnt lgkmcnt(0)
    s_barrier
    s_nop 1
    v_mfma_f32_16x16x32_bf16 v[16:19], v[136:139], v[168:171], v[16:19]
    v_cndmask_b32_e64 v251, 0, v194, s[62:63]
    v_mfma_f32_16x16x32_bf16 v[20:23], v[136:139], v[172:175], v[20:23]
    v_cmp_lt_i32_e64 s[62:63], -9, v195
    v_mfma_f32_16x16x32_bf16 v[24:27], v[152:155], v[140:143], v[24:27]
    v_cmp_lt_i32_e64 s[64:65], -8, v195
    v_mfma_f32_16x16x32_bf16 v[28:31], v[156:159], v[140:143], v[28:31]
    v_cmp_lt_i32_e64 s[66:67], -7, v195
    v_mfma_f32_16x16x32_bf16 v[32:35], v[160:163], v[140:143], v[32:35]
    s_nop 1
    v_mfma_f32_16x16x32_bf16 v[36:39], v[164:167], v[140:143], v[36:39]
    v_cndmask_b32_e64 v196, 0, v194, s[62:63]
    v_mfma_f32_16x16x32_bf16 v[40:43], v[140:143], v[168:171], v[40:43]
    v_cndmask_b32_e64 v197, 0, v194, s[64:65]
    v_mfma_f32_16x16x32_bf16 v[44:47], v[140:143], v[172:175], v[44:47]
    v_cndmask_b32_e64 v198, 0, v194, s[66:67]
    v_mfma_f32_16x16x32_bf16 v[48:51], v[152:155], v[144:147], v[48:51]
    v_cmp_lt_i32_e64 s[62:63], -6, v195
    v_mfma_f32_16x16x32_bf16 v[52:55], v[156:159], v[144:147], v[52:55]
    v_cmp_lt_i32_e64 s[64:65], -1, v195
    v_mfma_f32_16x16x32_bf16 v[56:59], v[160:163], v[144:147], v[56:59]
    v_cmp_lt_i32_e64 s[66:67], 0, v195
    v_mfma_f32_16x16x32_bf16 v[60:63], v[164:167], v[144:147], v[60:63]
    s_nop 1
    v_mfma_f32_16x16x32_bf16 v[64:67], v[144:147], v[168:171], v[64:67]
    v_cndmask_b32_e64 v199, 0, v194, s[62:63]
    v_mfma_f32_16x16x32_bf16 v[68:71], v[144:147], v[172:175], v[68:71]
    v_cndmask_b32_e64 v200, 0, v194, s[64:65]
    v_mfma_f32_16x16x32_bf16 v[72:75], v[152:155], v[148:151], v[72:75]
    v_cndmask_b32_e64 v201, 0, v194, s[66:67]
    v_mfma_f32_16x16x32_bf16 v[76:79], v[156:159], v[148:151], v[76:79]
    v_cmp_lt_i32_e64 s[62:63], 1, v195
    v_mfma_f32_16x16x32_bf16 v[80:83], v[160:163], v[148:151], v[80:83]
    v_cmp_lt_i32_e64 s[64:65], 2, v195
    v_mfma_f32_16x16x32_bf16 v[84:87], v[164:167], v[148:151], v[84:87]
    s_nop 1
    v_mfma_f32_16x16x32_bf16 v[88:91], v[148:151], v[168:171], v[88:91]
    v_cndmask_b32_e64 v202, 0, v194, s[62:63]
    v_mfma_f32_16x16x32_bf16 v[92:95], v[148:151], v[172:175], v[92:95]
    v_cndmask_b32_e64 v203, 0, v194, s[64:65]
    v_lshlrev_b32 v223, 4, v255
    s_lshl_b32 s54, s21, 3
    s_lshl_b32 s60, s24, 1
    s_add_u32 s60, s60, s23
    s_add_u32 s54, s54, s60
    s_lshl_b32 s29, s20, 18
    s_lshl_b32 s56, s54, 6
    s_add_u32 s56, s56, s20
    s_lshl_b32 s56, s56, 11
    s_add_u32 s56, s56, 0x800000
    s_add_u32 s55, s56, 65536
    s_cmp_lg_u32 s23, 0
    s_cbranch_scc1 L_tr_b
    s_lshl_b32 s61, s54, 12
    s_add_u32 s61, s61, s29
    s_lshl_b32 s62, s24, 13
    v_add_u32 v192, s62, v223
    v_add_u32 v193, s62, v254
    s_lshl_b32 s63, s24, 12
    s_add_u32 s63, s63, 147456
    v_add_u32 v194, s63, v254
    s_add_u32 s64, s61, 4096
    s_nop 4
    v_cvt_pk_bf16_f32 v96, v8, v9
    v_cvt_pk_bf16_f32 v98, v32, v33
    v_cvt_pk_bf16_f32 v97, v10, v11
    v_cvt_pk_bf16_f32 v99, v34, v35
    v_cvt_pk_bf16_f32 v100, v12, v13
    v_cvt_pk_bf16_f32 v102, v36, v37
    v_cvt_pk_bf16_f32 v101, v14, v15
    v_cvt_pk_bf16_f32 v103, v38, v39
    s_nop 0
    v_permlane16_swap_b32 v96, v98
    v_permlane16_swap_b32 v97, v99
    v_permlane16_swap_b32 v100, v102
    v_permlane16_swap_b32 v101, v103
    buffer_store_dwordx4 v[96:99], v223, s[12:15], s61 offen offset:0 sc1
    buffer_store_dwordx4 v[100:103], v223, s[12:15], s61 offen offset:1024 sc1
    v_cvt_pk_bf16_f32 v104, v16, v17
    v_cvt_pk_bf16_f32 v106, v20, v21
    v_cvt_pk_bf16_f32 v105, v18, v19
    v_cvt_pk_bf16_f32 v107, v22, v23
    v_cvt_pk_bf16_f32 v108, v40, v41
    v_cvt_pk_bf16_f32 v110, v44, v45
    v_cvt_pk_bf16_f32 v109, v42, v43
    v_cvt_pk_bf16_f32 v111, v46, v47
    s_nop 0
    v_permlane16_swap_b32 v104, v106
    v_permlane16_swap_b32 v105, v107
    v_permlane16_swap_b32 v108, v110
    v_permlane16_swap_b32 v109, v111
    buffer_store_dwordx4 v[104:107], v254, s[12:15], s61 offen offset:2048 sc1
    buffer_store_dwordx4 v[108:111], v254, s[12:15], s61 offen offset:3072 sc1
    ds_write_b128 v192, v[96:99] offset:0
    ds_write_b128 v192, v[100:103] offset:1024
    ds_write_b128 v193, v[104:107] offset:2048
    ds_write_b128 v193, v[108:111] offset:3072
    v_cvt_pk_bf16_f32 v112, v56, v57
    v_cvt_pk_bf16_f32 v114, v80, v81
    v_cvt_pk_bf16_f32 v113, v58, v59
    v_cvt_pk_bf16_f32 v115, v82, v83
    v_cvt_pk_bf16_f32 v116, v60, v61
    v_cvt_pk_bf16_f32 v118, v84, v85
    v_cvt_pk_bf16_f32 v117, v62, v63
    v_cvt_pk_bf16_f32 v119, v86, v87
    s_nop 0
    v_permlane16_swap_b32 v112, v114
    v_permlane16_swap_b32 v113, v115
    v_permlane16_swap_b32 v116, v118
    v_permlane16_swap_b32 v117, v119
    buffer_store_dwordx4 v[112:115], v223, s[12:15], s64 offen offset:0 sc1
    buffer_store_dwordx4 v[116:119], v223, s[12:15], s64 offen offset:1024 sc1
    v_cvt_pk_bf16_f32 v120, v64, v65
    v_cvt_pk_bf16_f32 v122, v68, v69
    v_cvt_pk_bf16_f32 v121, v66, v67
    v_cvt_pk_bf16_f32 v123, v70, v71
    v_cvt_pk_bf16_f32 v124, v88, v89
    v_cvt_pk_bf16_f32 v126, v92, v93
    v_cvt_pk_bf16_f32 v125, v90, v91
    v_cvt_pk_bf16_f32 v127, v94, v95
    s_nop 0
    v_permlane16_swap_b32 v120, v122
    v_permlane16_swap_b32 v121, v123
    v_permlane16_swap_b32 v124, v126
    v_permlane16_swap_b32 v125, v127
    buffer_store_dwordx4 v[120:123], v254, s[12:15], s64 offen offset:2048 sc1
    buffer_store_dwordx4 v[124:127], v254, s[12:15], s64 offen offset:3072 sc1
    ds_write_b128 v192, v[112:115] offset:4096
    ds_write_b128 v192, v[116:119] offset:5120
    ds_write_b128 v193, v[120:123] offset:6144
    ds_write_b128 v193, v[124:127] offset:7168
    v_mul_f32 v0, 0x3e8293ee, v0
    v_mul_f32 v1, 0x3e8293ee, v1
    v_mul_f32 v24, 0x3e8293ee, v24
    v_mul_f32 v25, 0x3e8293ee, v25
    v_mul_f32 v2, 0x3e8293ee, v2
    v_mul_f32 v3, 0x3e8293ee, v3
    v_mul_f32 v26, 0x3e8293ee, v26
    v_mul_f32 v27, 0x3e8293ee, v27
    v_mul_f32 v4, 0x3e8293ee, v4
    v_mul_f32 v5, 0x3e8293ee, v5
    v_mul_f32 v28, 0x3e8293ee, v28
    v_mul_f32 v29, 0x3e8293ee, v29
    v_mul_f32 v6, 0x3e8293ee, v6
    v_mul_f32 v7, 0x3e8293ee, v7
    v_mul_f32 v30, 0x3e8293ee, v30
    v_mul_f32 v31, 0x3e8293ee, v31
    v_cvt_pk_bf16_f32 v128, v0, v1
    v_cvt_pk_bf16_f32 v130, v24, v25
    v_cvt_pk_bf16_f32 v129, v2, v3
    v_cvt_pk_bf16_f32 v131, v26, v27
    v_cvt_pk_bf16_f32 v132, v4, v5
    v_cvt_pk_bf16_f32 v134, v28, v29
    v_cvt_pk_bf16_f32 v133, v6, v7
    v_cvt_pk_bf16_f32 v135, v30, v31
    s_nop 0
    v_permlane16_swap_b32 v128, v130
    v_permlane16_swap_b32 v129, v131
    v_permlane16_swap_b32 v132, v134
    v_permlane16_swap_b32 v133, v135
    ds_write_b128 v194, v[128:131] offset:0
    ds_write_b128 v194, v[132:135] offset:1024
    v_mul_f32 v48, 0x3e8293ee, v48
    v_mul_f32 v49, 0x3e8293ee, v49
    v_mul_f32 v72, 0x3e8293ee, v72
    v_mul_f32 v73, 0x3e8293ee, v73
    v_mul_f32 v50, 0x3e8293ee, v50
    v_mul_f32 v51, 0x3e8293ee, v51
    v_mul_f32 v74, 0x3e8293ee, v74
    v_mul_f32 v75, 0x3e8293ee, v75
    v_mul_f32 v52, 0x3e8293ee, v52
    v_mul_f32 v53, 0x3e8293ee, v53
    v_mul_f32 v76, 0x3e8293ee, v76
    v_mul_f32 v77, 0x3e8293ee, v77
    v_mul_f32 v54, 0x3e8293ee, v54
    v_mul_f32 v55, 0x3e8293ee, v55
    v_mul_f32 v78, 0x3e8293ee, v78
    v_mul_f32 v79, 0x3e8293ee, v79
    v_cvt_pk_bf16_f32 v136, v48, v49
    v_cvt_pk_bf16_f32 v138, v72, v73
    v_cvt_pk_bf16_f32 v137, v50, v51
    v_cvt_pk_bf16_f32 v139, v74, v75
    v_cvt_pk_bf16_f32 v140, v52, v53
    v_cvt_pk_bf16_f32 v142, v76, v77
    v_cvt_pk_bf16_f32 v141, v54, v55
    v_cvt_pk_bf16_f32 v143, v78, v79
    s_nop 0
    v_permlane16_swap_b32 v136, v138
    v_permlane16_swap_b32 v137, v139
    v_permlane16_swap_b32 v140, v142
    v_permlane16_swap_b32 v141, v143
    ds_write_b128 v194, v[136:139] offset:2048
    ds_write_b128 v194, v[140:143] offset:3072
    s_branch L_tr_join
L_tr_b:
    s_mul_i32 s61, s24, 12288
    s_add_u32 s61, s61, 98304
    v_add_u32 v192, s61, v223
    v_add_u32 v193, s61, v254
    s_lshl_b32 s62, s20, 3
    s_add_u32 s62, s62, s21
    s_lshl_b32 s62, s62, 1
    s_lshr_b32 s63, s24, 1
    s_add_u32 s62, s62, s63
    s_lshl_b32 s62, s62, 12
    s_add_u32 s62, s62, 0x1000000
    s_nop 2
    v_cvt_pk_bf16_f32 v96, v8, v9
    v_cvt_pk_bf16_f32 v98, v32, v33
    v_cvt_pk_bf16_f32 v97, v10, v11
    v_cvt_pk_bf16_f32 v99, v34, v35
    v_cvt_pk_bf16_f32 v100, v12, v13
    v_cvt_pk_bf16_f32 v102, v36, v37
    v_cvt_pk_bf16_f32 v101, v14, v15
    v_cvt_pk_bf16_f32 v103, v38, v39
    s_nop 0
    v_permlane16_swap_b32 v96, v98
    v_permlane16_swap_b32 v97, v99
    v_permlane16_swap_b32 v100, v102
    v_permlane16_swap_b32 v101, v103
    v_cvt_pk_bf16_f32 v104, v16, v17
    v_cvt_pk_bf16_f32 v106, v20, v21
    v_cvt_pk_bf16_f32 v105, v18, v19
    v_cvt_pk_bf16_f32 v107, v22, v23
    v_cvt_pk_bf16_f32 v108, v40, v41
    v_cvt_pk_bf16_f32 v110, v44, v45
    v_cvt_pk_bf16_f32 v109, v42, v43
    v_cvt_pk_bf16_f32 v111, v46, v47
    s_nop 0
    v_permlane16_swap_b32 v104, v106
    v_permlane16_swap_b32 v105, v107
    v_permlane16_swap_b32 v108, v110
    v_permlane16_swap_b32 v109, v111
    s_bitcmp1_b32 s24, 0
    s_cbranch_scc0 L_tr_nohalo
    buffer_store_dwordx4 v[96:99], v223, s[12:15], s62 offen offset:0 sc1
    buffer_store_dwordx4 v[100:103], v223, s[12:15], s62 offen offset:1024 sc1
    buffer_store_dwordx4 v[108:111], v254, s[12:15], s62 offen offset:2048 sc1
L_tr_nohalo:
    ds_write_b128 v192, v[96:99] offset:8192
    ds_write_b128 v192, v[100:103] offset:9216
    ds_write_b128 v193, v[104:107] offset:10240
    ds_write_b128 v193, v[108:111] offset:11264
    v_mul_f32 v0, 0x3e8293ee, v0
    v_mul_f32 v1, 0x3e8293ee, v1
    v_mul_f32 v24, 0x3e8293ee, v24
    v_mul_f32 v25, 0x3e8293ee, v25
    v_mul_f32 v2, 0x3e8293ee, v2
    v_mul_f32 v3, 0x3e8293ee, v3
    v_mul_f32 v26, 0x3e8293ee, v26
    v_mul_f32 v27, 0x3e8293ee, v27
    v_mul_f32 v4, 0x3e8293ee, v4
    v_mul_f32 v5, 0x3e8293ee, v5
    v_mul_f32 v28, 0x3e8293ee, v28
    v_mul_f32 v29, 0x3e8293ee, v29
    v_mul_f32 v6, 0x3e8293ee, v6
    v_mul_f32 v7, 0x3e8293ee, v7
    v_mul_f32 v30, 0x3e8293ee, v30
    v_mul_f32 v31, 0x3e8293ee, v31
    v_cvt_pk_bf16_f32 v112, v0, v1
    v_cvt_pk_bf16_f32 v114, v24, v25
    v_cvt_pk_bf16_f32 v113, v2, v3
    v_cvt_pk_bf16_f32 v115, v26, v27
    v_cvt_pk_bf16_f32 v116, v4, v5
    v_cvt_pk_bf16_f32 v118, v28, v29
    v_cvt_pk_bf16_f32 v117, v6, v7
    v_cvt_pk_bf16_f32 v119, v30, v31
    s_nop 0
    v_permlane16_swap_b32 v112, v114
    v_permlane16_swap_b32 v113, v115
    v_permlane16_swap_b32 v116, v118
    v_permlane16_swap_b32 v117, v119
    ds_write_b128 v193, v[112:115] offset:6144
    ds_write_b128 v193, v[116:119] offset:7168
    v_cvt_pk_bf16_f32 v120, v56, v57
    v_cvt_pk_bf16_f32 v122, v80, v81
    v_cvt_pk_bf16_f32 v121, v58, v59
    v_cvt_pk_bf16_f32 v123, v82, v83
    v_cvt_pk_bf16_f32 v124, v60, v61
    v_cvt_pk_bf16_f32 v126, v84, v85
    v_cvt_pk_bf16_f32 v125, v62, v63
    v_cvt_pk_bf16_f32 v127, v86, v87
    s_nop 0
    v_permlane16_swap_b32 v120, v122
    v_permlane16_swap_b32 v121, v123
    v_permlane16_swap_b32 v124, v126
    v_permlane16_swap_b32 v125, v127
    v_cvt_pk_bf16_f32 v128, v64, v65
    v_cvt_pk_bf16_f32 v130, v68, v69
    v_cvt_pk_bf16_f32 v129, v66, v67
    v_cvt_pk_bf16_f32 v131, v70, v71
    v_cvt_pk_bf16_f32 v132, v88, v89
    v_cvt_pk_bf16_f32 v134, v92, v93
    v_cvt_pk_bf16_f32 v133, v90, v91
    v_cvt_pk_bf16_f32 v135, v94, v95
    s_nop 0
    v_permlane16_swap_b32 v128, v130
    v_permlane16_swap_b32 v129, v131
    v_permlane16_swap_b32 v132, v134
    v_permlane16_swap_b32 v133, v135
    ds_write_b128 v192, v[120:123] offset:2048
    ds_write_b128 v192, v[124:127] offset:3072
    ds_write_b128 v193, v[128:131] offset:4096
    ds_write_b128 v193, v[132:135] offset:5120
    v_mul_f32 v48, 0x3e8293ee, v48
    v_mul_f32 v49, 0x3e8293ee, v49
    v_mul_f32 v72, 0x3e8293ee, v72
    v_mul_f32 v73, 0x3e8293ee, v73
    v_mul_f32 v50, 0x3e8293ee, v50
    v_mul_f32 v51, 0x3e8293ee, v51
    v_mul_f32 v74, 0x3e8293ee, v74
    v_mul_f32 v75, 0x3e8293ee, v75
    v_mul_f32 v52, 0x3e8293ee, v52
    v_mul_f32 v53, 0x3e8293ee, v53
    v_mul_f32 v76, 0x3e8293ee, v76
    v_mul_f32 v77, 0x3e8293ee, v77
    v_mul_f32 v54, 0x3e8293ee, v54
    v_mul_f32 v55, 0x3e8293ee, v55
    v_mul_f32 v78, 0x3e8293ee, v78
    v_mul_f32 v79, 0x3e8293ee, v79
    v_cvt_pk_bf16_f32 v136, v48, v49
    v_cvt_pk_bf16_f32 v138, v72, v73
    v_cvt_pk_bf16_f32 v137, v50, v51
    v_cvt_pk_bf16_f32 v139, v74, v75
    v_cvt_pk_bf16_f32 v140, v52, v53
    v_cvt_pk_bf16_f32 v142, v76, v77
    v_cvt_pk_bf16_f32 v141, v54, v55
    v_cvt_pk_bf16_f32 v143, v78, v79
    s_nop 0
    v_permlane16_swap_b32 v136, v138
    v_permlane16_swap_b32 v137, v139
    v_permlane16_swap_b32 v140, v142
    v_permlane16_swap_b32 v141, v143
    ds_write_b128 v193, v[136:139] offset:0
    ds_write_b128 v193, v[140:143] offset:1024
L_tr_join:
    s_waitcnt vmcnt(8)
    s_cmp_lg_u32 s23, 0
    s_cbranch_scc0 L_tr_n0
    s_waitcnt vmcnt(3)
    s_bitcmp1_b32 s24, 0
    s_cbranch_scc1 L_tr_n0
    s_waitcnt vmcnt(0)
L_tr_n0:
    v_readfirstlane_b32 s26, v191
    s_mov_b32 s60, 32768
L_nonce_poll:
    s_cmp_lg_u32 s26, 0
    s_cbranch_scc1 L_nonce_ok
    s_sub_u32 s60, s60, 1
    s_cmp_eq_u32 s60, 0
    s_cbranch_scc1 L_nonce_ok
    buffer_load_dword v191, v253, s[16:19], 0 offen sc1
    s_waitcnt vmcnt(0)
    v_readfirstlane_b32 s26, v191
    s_branch L_nonce_poll
L_nonce_ok:
    s_mov_b32 s4, s42
    s_mov_b32 s5, s43
    s_mov_b32 s6, 0x200000
    s_mov_b32 s7, 0x20000
    s_mov_b32 s8, s36
    s_mov_b32 s9, s37
    s_mov_b32 s10, 0x200000
    s_mov_b32 s11, 0x20000
    s_mov_b32 s16, s46
    s_mov_b32 s17, s47
    s_mov_b32 s18, 0x400000
    s_mov_b32 s19, 0x20000
    v_mov_b32 v44, 0xdddddddd
    v_bfe_u32 v192, v255, 2, 1
    v_mov_b32 v193, 0x3f803f80
    v_mul_lo_u32 v42, v192, v193
    v_sub_u32 v40, v193, v42
    v_mov_b32 v43, v42
    v_mov_b32 v41, v40
    s_lshl_b32 s53, s22, 12
    v_add_u32 v47, s53, v254
    s_lshl_b32 s60, s23, 14
    v_add_u32 v220, s60, v254
    v_mov_b32 v45, v220
    v_add_u32 v46, 32768, v220
    s_mov_b32 s31, 32768
    s_add_u32 s28, s21, 1
    s_and_b32 s28, s28, 7
    s_lshl_b32 s28, s28, 15
    s_mov_b32 s30, 32768
    v_and_b32 v222, 7, v255
    v_lshlrev_b32 v222, 8, v222
    s_lshl_b32 s62, s20, 11
    s_add_u32 s62, s62, 0x1210000
    s_lshl_b32 s63, s21, 8
    s_add_u32 s63, s63, s62
    s_waitcnt vmcnt(0) lgkmcnt(0)
    s_barrier
    s_cmp_lg_u32 s22, 0
    s_cbranch_scc1 L_fs_f1
    v_mov_b32 v207, s26
    v_lshlrev_b32 v206, 2, v255
    buffer_store_dword v207, v206, s[12:15], s63 offen sc1
L_fs_f1:
    s_cmp_eq_u32 s23, 0
    s_cbranch_scc1 L_tr_haveq
    s_lshl_b32 s60, s24, 12
    s_add_u32 s60, s60, 147456
    v_add_u32 v192, s60, v254
    ds_read_b128 v[128:131], v192 offset:2048
    ds_read_b128 v[132:135], v192 offset:3072
    ds_read_b128 v[136:139], v192 offset:0
    ds_read_b128 v[140:143], v192 offset:1024
L_tr_haveq:
    s_lshl_b32 s60, s24, 1
    s_add_u32 s60, s60, s23
    s_and_b32 s61, s60, 3
    s_cmp_eq_u32 s61, 0
    s_cselect_b32 s61, 1, 0
    s_cmp_eq_u32 s21, 0
    s_cselect_b32 s57, s61, 0
    s_cselect_b32 s58, 0, s61
    ds_read_b128 v[160:163], v254 offset:0
    ds_read_b128 v[164:167], v254 offset:1024
    ds_read_b128 v[176:179], v45 offset:0
    ds_read_b128 v[180:183], v45 offset:1024
    v_mov_b32 v184, 0
    v_mov_b32 v185, 0
    v_mov_b32 v186, 0
    v_mov_b32 v187, 0
    v_mov_b32 v188, 0
    v_mov_b32 v189, 0
    v_mov_b32 v190, 0
    v_mov_b32 v191, 0
    v_mov_b32 v144, 0
    v_mov_b32 v145, 0
    v_mov_b32 v146, 0
    v_mov_b32 v147, 0
    v_mov_b32 v148, 0
    v_mov_b32 v149, 0
    v_mov_b32 v150, 0
    v_mov_b32 v151, 0
    v_mov_b32 v152, 0
    v_mov_b32 v153, 0
    v_mov_b32 v154, 0
    v_mov_b32 v155, 0
    v_mov_b32 v156, 0
    v_mov_b32 v157, 0
    v_mov_b32 v158, 0
    v_mov_b32 v159, 0
    s_waitcnt lgkmcnt(2)
    v_mfma_f32_32x32x16_bf16 v[96:111], v[160:163], v[128:131], 0
    v_mfma_f32_32x32x16_bf16 v[112:127], v[160:163], v[136:139], 0
    v_mfma_f32_32x32x16_bf16 v[96:111], v[164:167], v[132:135], v[96:111]
    v_mfma_f32_32x32x16_bf16 v[112:127], v[164:167], v[140:143], v[112:127]
    v_mov_b32 v0, 0
    v_mov_b32 v1, 0
    v_mov_b32 v2, 0
    v_mov_b32 v3, 0
    v_mov_b32 v4, 0
    v_mov_b32 v5, 0
    v_mov_b32 v6, 0
    v_mov_b32 v7, 0
    v_mov_b32 v8, 0
    v_mov_b32 v9, 0
    v_mov_b32 v10, 0
    v_mov_b32 v11, 0
    v_mov_b32 v12, 0
    v_mov_b32 v13, 0
    v_mov_b32 v14, 0
    v_mov_b32 v15, 0
    v_mov_b32 v16, 0
    v_mov_b32 v17, 0
    v_mov_b32 v18, 0
    v_mov_b32 v19, 0
    v_mov_b32 v20, 0
    v_mov_b32 v21, 0
    v_mov_b32 v22, 0
    v_mov_b32 v23, 0
    v_mov_b32 v24, 0
    v_mov_b32 v25, 0
    v_mov_b32 v26, 0
    v_mov_b32 v27, 0
    v_mov_b32 v28, 0
    v_mov_b32 v29, 0
    v_mov_b32 v30, 0
    v_mov_b32 v31, 0
    v_mov_b32 v32, 0
    v_mov_b32 v33, 0
    v_mov_b32 v34, 0
    v_mov_b32 v35, 0
    v_mov_b32 v36, 0
    v_mov_b32 v37, 0
    v_mov_b32 v38, 0
    v_mov_b32 v39, 0
    v_max3_f32 v192, v96, v97, v98
    v_max3_f32 v194, v112, v113, v114
    v_max3_f32 v192, v192, v99, v100
    v_max3_f32 v194, v194, v115, v116
    v_max3_f32 v192, v192, v101, v102
    v_max3_f32 v194, v194, v117, v118
    v_max3_f32 v192, v192, v103, v104
    v_max3_f32 v194, v194, v119, v120
    v_max3_f32 v192, v192, v105, v106
    v_max3_f32 v194, v194, v121, v122
    v_max3_f32 v192, v192, v107, v108
    v_max3_f32 v194, v194, v123, v124
    v_max3_f32 v192, v192, v109, v110
    v_max3_f32 v194, v194, v125, v126
    v_max_f32 v192, v192, v111
    v_max_f32 v194, v194, v127
    v_mov_b32 v193, v192
    v_mov_b32 v195, v194
    s_nop 1
    v_permlane32_swap_b32 v192, v193
    v_permlane32_swap_b32 v194, v195
    s_nop 1
    v_max_f32 v192, v192, v193
    v_max_f32 v194, v194, v195
    v_sub_f32 v48, 0, v192
    v_sub_f32 v49, 0, v192
    v_sub_f32 v50, 0, v192
    v_sub_f32 v51, 0, v192
    v_sub_f32 v52, 0, v192
    v_sub_f32 v53, 0, v192
    v_sub_f32 v54, 0, v192
    v_sub_f32 v55, 0, v192
    v_sub_f32 v56, 0, v192
    v_sub_f32 v57, 0, v192
    v_sub_f32 v58, 0, v192
    v_sub_f32 v59, 0, v192
    v_sub_f32 v60, 0, v192
    v_sub_f32 v61, 0, v192
    v_sub_f32 v62, 0, v192
    v_sub_f32 v63, 0, v192
    s_waitcnt lgkmcnt(0)
    ds_read_b128 v[160:163], v45 offset:4096
    ds_read_b128 v[164:167], v45 offset:5120
    ds_read_b128 v[168:171], v45 offset:2048
    ds_read_b128 v[172:175], v45 offset:3072
    v_mfma_f32_32x32x16_bf16 v[80:95], v[176:179], v[128:131], v[48:63]
    v_mfma_f32_32x32x16_bf16 v[80:95], v[180:183], v[132:135], v[80:95]
    v_sub_f32 v64, 0, v194
    v_sub_f32 v65, 0, v194
    v_sub_f32 v66, 0, v194
    v_sub_f32 v67, 0, v194
    v_sub_f32 v68, 0, v194
    v_sub_f32 v69, 0, v194
    v_sub_f32 v70, 0, v194
    v_sub_f32 v71, 0, v194
    v_sub_f32 v72, 0, v194
    v_sub_f32 v73, 0, v194
    v_sub_f32 v74, 0, v194
    v_sub_f32 v75, 0, v194
    v_sub_f32 v76, 0, v194
    v_sub_f32 v77, 0, v194
    v_sub_f32 v78, 0, v194
    v_sub_f32 v79, 0, v194
    s_nop 3
    v_mfma_f32_32x32x16_bf16 v[112:127], v[176:179], v[136:139], v[64:79]
    v_exp_f32 v80, v80
    v_exp_f32 v81, v81
    v_exp_f32 v82, v82
    v_mfma_f32_32x32x16_bf16 v[112:127], v[180:183], v[140:143], v[112:127]
    v_exp_f32 v83, v83
    v_exp_f32 v84, v84
    v_exp_f32 v85, v85
    v_smfmac_f32_32x32x32_bf16 v[16:31], v[184:187], v[144:151], v44
    v_exp_f32 v86, v86
    v_exp_f32 v87, v87
    v_smfmac_f32_16x16x64_bf16 v[36:39], v[40:43], v[144:151], v44
    v_exp_f32 v88, v88
    v_exp_f32 v89, v89
    v_exp_f32 v90, v90
    v_smfmac_f32_32x32x32_bf16 v[16:31], v[188:191], v[152:159], v44
    v_exp_f32 v91, v91
    v_exp_f32 v92, v92
    v_exp_f32 v93, v93
    v_smfmac_f32_16x16x64_bf16 v[36:39], v[40:43], v[152:159], v44
    v_exp_f32 v94, v94
    v_exp_f32 v95, v95
    s_waitcnt lgkmcnt(0)
    v_mfma_f32_32x32x16_bf16 v[96:111], v[160:163], v[128:131], v[48:63]
    v_exp_f32 v112, v112
    v_exp_f32 v113, v113
    ds_read_b128 v[176:179], v45 offset:8192
    v_exp_f32 v114, v114
    v_mfma_f32_32x32x16_bf16 v[96:111], v[164:167], v[132:135], v[96:111]
    v_exp_f32 v115, v115
    ds_read_b128 v[180:183], v45 offset:9216
    v_exp_f32 v116, v116
    v_exp_f32 v117, v117
    ds_read_b128 v[184:187], v45 offset:6144
    v_smfmac_f32_32x32x32_bf16 v[0:15], v[168:171], v[80:87], v44
    v_exp_f32 v118, v118
    v_exp_f32 v119, v119
    ds_read_b128 v[188:191], v45 offset:7168
    v_smfmac_f32_16x16x64_bf16 v[32:35], v[40:43], v[80:87], v44
    v_exp_f32 v120, v120
    v_exp_f32 v121, v121
    v_exp_f32 v122, v122
    v_smfmac_f32_32x32x32_bf16 v[0:15], v[172:175], v[88:95], v44
    v_exp_f32 v123, v123
    v_exp_f32 v124, v124
    v_exp_f32 v125, v125
    v_smfmac_f32_16x16x64_bf16 v[32:35], v[40:43], v[88:95], v44
    v_exp_f32 v126, v126
    v_exp_f32 v127, v127
    s_lshl_b32 s62, s20, 11
    s_add_u32 s62, s62, 0x1210000
    s_lshl_b32 s63, s21, 8
    s_add_u32 s63, s63, s62
    v_mfma_f32_32x32x16_bf16 v[144:159], v[160:163], v[136:139], v[64:79]
    v_exp_f32 v96, v96
    v_exp_f32 v97, v97
    v_exp_f32 v98, v98
    v_mfma_f32_32x32x16_bf16 v[144:159], v[164:167], v[140:143], v[144:159]
    v_exp_f32 v99, v99
    v_exp_f32 v100, v100
    v_exp_f32 v101, v101
    v_smfmac_f32_32x32x32_bf16 v[16:31], v[168:171], v[112:119], v44
    v_exp_f32 v102, v102
    v_exp_f32 v103, v103
    v_smfmac_f32_16x16x64_bf16 v[36:39], v[40:43], v[112:119], v44
    v_exp_f32 v104, v104
    v_exp_f32 v105, v105
    v_exp_f32 v106, v106
    v_smfmac_f32_32x32x32_bf16 v[16:31], v[172:175], v[120:127], v44
    v_exp_f32 v107, v107
    v_exp_f32 v108, v108
    v_exp_f32 v109, v109
    v_smfmac_f32_16x16x64_bf16 v[36:39], v[40:43], v[120:127], v44
    v_exp_f32 v110, v110
    v_exp_f32 v111, v111
    s_waitcnt lgkmcnt(0)
    v_mfma_f32_32x32x16_bf16 v[80:95], v[176:179], v[128:131], v[48:63]
    v_exp_f32 v144, v144
    v_exp_f32 v145, v145
    ds_read_b128 v[160:163], v45 offset:12288
    v_exp_f32 v146, v146
    v_mfma_f32_32x32x16_bf16 v[80:95], v[180:183], v[132:135], v[80:95]
    v_exp_f32 v147, v147
    ds_read_b128 v[164:167], v45 offset:13312
    v_exp_f32 v148, v148
    v_exp_f32 v149, v149
    ds_read_b128 v[168:171], v45 offset:10240
    v_smfmac_f32_32x32x32_bf16 v[0:15], v[184:187], v[96:103], v44
    v_exp_f32 v150, v150
    v_exp_f32 v151, v151
    ds_read_b128 v[172:175], v45 offset:11264
    v_smfmac_f32_16x16x64_bf16 v[32:35], v[40:43], v[96:103], v44
    v_exp_f32 v152, v152
    v_exp_f32 v153, v153
    v_exp_f32 v154, v154
    v_smfmac_f32_32x32x32_bf16 v[0:15], v[188:191], v[104:111], v44
    v_exp_f32 v155, v155
    v_exp_f32 v156, v156
    v_exp_f32 v157, v157
    v_smfmac_f32_16x16x64_bf16 v[32:35], v[40:43], v[104:111], v44
    v_exp_f32 v158, v158
    v_exp_f32 v159, v159
    v_mfma_f32_32x32x16_bf16 v[112:127], v[176:179], v[136:139], v[64:79]
    v_exp_f32 v80, v80
    v_exp_f32 v81, v81
    v_exp_f32 v82, v82
    v_mfma_f32_32x32x16_bf16 v[112:127], v[180:183], v[140:143], v[112:127]
    v_exp_f32 v83, v83
    v_exp_f32 v84, v84
    v_exp_f32 v85, v85
    v_smfmac_f32_32x32x32_bf16 v[16:31], v[184:187], v[144:151], v44
    v_exp_f32 v86, v86
    v_exp_f32 v87, v87
    v_smfmac_f32_16x16x64_bf16 v[36:39], v[40:43], v[144:151], v44
    v_exp_f32 v88, v88
    v_exp_f32 v89, v89
    v_exp_f32 v90, v90
    v_smfmac_f32_32x32x32_bf16 v[16:31], v[188:191], v[152:159], v44
    v_exp_f32 v91, v91
    v_exp_f32 v92, v92
    v_exp_f32 v93, v93
    v_smfmac_f32_16x16x64_bf16 v[36:39], v[40:43], v[152:159], v44
    v_exp_f32 v94, v94
    v_exp_f32 v95, v95
    s_waitcnt lgkmcnt(0)
    v_mfma_f32_32x32x16_bf16 v[96:111], v[160:163], v[128:131], v[48:63]
    v_exp_f32 v112, v112
    v_exp_f32 v113, v113
    ds_read_b128 v[184:187], v45 offset:14336
    v_exp_f32 v114, v114
    v_mfma_f32_32x32x16_bf16 v[96:111], v[164:167], v[132:135], v[96:111]
    v_exp_f32 v115, v115
    ds_read_b128 v[188:191], v45 offset:15360
    v_exp_f32 v116, v116
    v_exp_f32 v117, v117
    v_smfmac_f32_32x32x32_bf16 v[0:15], v[168:171], v[80:87], v44
    v_exp_f32 v118, v118
    v_exp_f32 v119, v119
    v_smfmac_f32_16x16x64_bf16 v[32:35], v[40:43], v[80:87], v44
    v_exp_f32 v120, v120
    v_exp_f32 v121, v121
    v_exp_f32 v122, v122
    v_smfmac_f32_32x32x32_bf16 v[0:15], v[172:175], v[88:95], v44
    v_exp_f32 v123, v123
    v_exp_f32 v124, v124
    v_exp_f32 v125, v125
    v_smfmac_f32_16x16x64_bf16 v[32:35], v[40:43], v[88:95], v44
    v_exp_f32 v126, v126
    v_exp_f32 v127, v127
    buffer_load_dword v221, v222, s[12:15], s62 offen sc1
    v_mfma_f32_32x32x16_bf16 v[144:159], v[160:163], v[136:139], v[64:79]
    v_exp_f32 v96, v96
    v_exp_f32 v97, v97
    v_exp_f32 v98, v98
    v_mfma_f32_32x32x16_bf16 v[144:159], v[164:167], v[140:143], v[144:159]
    v_exp_f32 v99, v99
    v_exp_f32 v100, v100
    v_exp_f32 v101, v101
    v_smfmac_f32_32x32x32_bf16 v[16:31], v[168:171], v[112:119], v44
    v_exp_f32 v102, v102
    v_exp_f32 v103, v103
    v_smfmac_f32_16x16x64_bf16 v[36:39], v[40:43], v[112:119], v44
    v_exp_f32 v104, v104
    v_exp_f32 v105, v105
    v_exp_f32 v106, v106
    v_smfmac_f32_32x32x32_bf16 v[16:31], v[172:175], v[120:127], v44
    v_exp_f32 v107, v107
    v_exp_f32 v108, v108
    v_exp_f32 v109, v109
    v_smfmac_f32_16x16x64_bf16 v[36:39], v[40:43], v[120:127], v44
    v_exp_f32 v110, v110
    v_exp_f32 v111, v111
    s_waitcnt lgkmcnt(0)
    v_exp_f32 v144, v144
    v_exp_f32 v145, v145
    v_exp_f32 v146, v146
    v_exp_f32 v147, v147
    v_exp_f32 v148, v148
    v_exp_f32 v149, v149
    v_smfmac_f32_32x32x32_bf16 v[0:15], v[184:187], v[96:103], v44
    v_exp_f32 v150, v150
    v_exp_f32 v151, v151
    v_smfmac_f32_16x16x64_bf16 v[32:35], v[40:43], v[96:103], v44
    v_exp_f32 v152, v152
    v_exp_f32 v153, v153
    v_exp_f32 v154, v154
    v_smfmac_f32_32x32x32_bf16 v[0:15], v[188:191], v[104:111], v44
    v_exp_f32 v155, v155
    v_exp_f32 v156, v156
    v_exp_f32 v157, v157
    v_smfmac_f32_16x16x64_bf16 v[32:35], v[40:43], v[104:111], v44
    v_exp_f32 v158, v158
    v_exp_f32 v159, v159
    s_mov_b32 s60, 32768
    s_waitcnt vmcnt(0)
    s_branch L_poll_f1_chk
L_poll_f1:
    s_waitcnt vmcnt(0)
L_poll_f1_chk:
    v_cmp_ne_u32 vcc, s26, v221
    s_nop 4
    s_cbranch_vccz L_poll_f1_ok
    s_sub_u32 s60, s60, 1
    s_cmp_eq_u32 s60, 0
    s_cbranch_scc1 L_poll_f1_ok
    s_sleep 2
    buffer_load_dword v221, v222, s[12:15], s62 offen sc1
    s_branch L_poll_f1
L_poll_f1_ok:
    s_cmp_eq_u32 s58, 0
    s_cbranch_scc1 L_nohalo_ld
    s_lshl_b32 s63, s20, 3
    s_add_u32 s63, s63, s21
    s_sub_u32 s63, s63, 1
    s_lshl_b32 s63, s63, 1
    s_lshr_b32 s64, s24, 1
    s_add_u32 s63, s63, s64
    s_lshl_b32 s63, s63, 12
    s_add_u32 s63, s63, 0x1000000
    buffer_load_dwordx4 v[208:211], v254, s[12:15], s63 offen offset:0 sc1
    buffer_load_dwordx4 v[212:215], v254, s[12:15], s63 offen offset:1024 sc1
    buffer_load_dwordx4 v[216:219], v254, s[12:15], s63 offen offset:2048 sc1
L_nohalo_ld:
    s_add_u32 m0, s53, s30
    s_add_u32 s61, s29, s28
    buffer_load_dwordx4 v47, s[12:15], s61 offen sc1 lds
    buffer_load_dwordx4 v47, s[12:15], s61 offen offset:1024 sc1 lds
    buffer_load_dwordx4 v47, s[12:15], s61 offen offset:2048 sc1 lds
    buffer_load_dwordx4 v47, s[12:15], s61 offen offset:3072 sc1 lds
    s_add_u32 s28, s28, 32768
    s_and_b32 s28, s28, 262143
    s_add_u32 s30, s30, 32768
    s_cmp_eq_u32 s30, 98304
    s_cselect_b32 s30, 0, s30
    s_nop 1
    v_smfmac_f32_32x32x32_bf16 v[16:31], v[184:187], v[144:151], v44
    v_smfmac_f32_16x16x64_bf16 v[36:39], v[40:43], v[144:151], v44
    v_smfmac_f32_32x32x32_bf16 v[16:31], v[188:191], v[152:159], v44
    v_smfmac_f32_16x16x64_bf16 v[36:39], v[40:43], v[152:159], v44
    s_lshl_b32 s60, s24, 1
    s_add_u32 s60, s60, s23
    s_mul_i32 s61, s60, 6144
    s_add_u32 s61, s61, 98304
    v_add_u32 v192, s61, v254
    ds_read_b128 v[160:163], v192 offset:0
    ds_read_b128 v[164:167], v192 offset:1024
    ds_read_b128 v[168:171], v192 offset:2048
    ds_read_b128 v[172:175], v192 offset:3072
    ds_read_b128 v[176:179], v192 offset:4096
    ds_read_b128 v[180:183], v192 offset:5120
    s_cmp_eq_u32 s58, 1
    s_cbranch_scc1 L_b_halo
    s_and_b32 s62, s60, 3
    s_cmp_eq_u32 s62, 0
    s_cselect_b32 s62, 0, 6144
    s_sub_u32 s61, s61, s62
    v_add_u32 v193, s61, v254
    ds_read_b128 v[208:211], v193 offset:2048
    ds_read_b128 v[212:215], v193 offset:3072
    ds_read_b128 v[216:219], v193 offset:5120
    s_branch L_b_ops
L_b_halo:
    s_waitcnt vmcnt(4)
L_b_ops:
    s_add_u32 m0, s53, s30
    s_add_u32 s61, s29, s28
    buffer_load_dwordx4 v47, s[12:15], s61 offen sc1 lds
    buffer_load_dwordx4 v47, s[12:15], s61 offen offset:1024 sc1 lds
    buffer_load_dwordx4 v47, s[12:15], s61 offen offset:2048 sc1 lds
    buffer_load_dwordx4 v47, s[12:15], s61 offen offset:3072 sc1 lds
    s_add_u32 s28, s28, 32768
    s_and_b32 s28, s28, 262143
    s_add_u32 s30, s30, 32768
    s_cmp_eq_u32 s30, 98304
    s_cselect_b32 s30, 0, s30
    v_mov_b32 v112, 0
    v_mov_b32 v113, 0
    v_mov_b32 v114, 0
    v_mov_b32 v115, 0
    v_mov_b32 v116, 0
    v_mov_b32 v117, 0
    v_mov_b32 v118, 0
    v_mov_b32 v119, 0
    v_mov_b32 v120, 0
    v_mov_b32 v121, 0
    v_mov_b32 v122, 0
    v_mov_b32 v123, 0
    v_mov_b32 v124, 0
    v_mov_b32 v125, 0
    v_mov_b32 v126, 0
    v_mov_b32 v127, 0
    v_mov_b32 v144, 0
    v_mov_b32 v145, 0
    v_mov_b32 v146, 0
    v_mov_b32 v147, 0
    s_waitcnt lgkmcnt(0)
    v_mfma_f32_32x32x16_bf16 v[80:95], v[168:171], v[160:163], v[236:251]
    v_mfma_f32_32x32x16_bf16 v[96:111], v[208:211], v[160:163], v[188:203]
    v_mfma_f32_32x32x16_bf16 v[80:95], v[172:175], v[164:167], v[80:95]
    v_mfma_f32_32x32x16_bf16 v[96:111], v[212:215], v[164:167], v[96:111]
    s_nop 7
    s_nop 3
    v_max3_f32 v192, v80, v81, v82
    v_max3_f32 v192, v192, v83, v84
    v_max3_f32 v192, v192, v85, v86
    v_max3_f32 v192, v192, v87, v88
    v_max3_f32 v192, v192, v89, v90
    v_max3_f32 v192, v192, v91, v92
    v_max3_f32 v192, v192, v93, v94
    v_max3_f32 v192, v192, v95, v104
    v_max3_f32 v192, v192, v105, v106
    v_max3_f32 v192, v192, v107, v108
    v_max3_f32 v192, v192, v109, v110
    v_max_f32 v192, v192, v111
    v_mov_b32 v193, v192
    s_nop 1
    v_permlane32_swap_b32 v192, v193
    s_nop 1
    v_max_f32 v192, v192, v193
    v_sub_f32 v80, v80, v192
    v_sub_f32 v81, v81, v192
    v_sub_f32 v82, v82, v192
    v_sub_f32 v83, v83, v192
    v_sub_f32 v84, v84, v192
    v_sub_f32 v85, v85, v192
    v_sub_f32 v86, v86, v192
    v_sub_f32 v87, v87, v192
    v_sub_f32 v88, v88, v192
    v_sub_f32 v89, v89, v192
    v_sub_f32 v90, v90, v192
    v_sub_f32 v91, v91, v192
    v_sub_f32 v92, v92, v192
    v_sub_f32 v93, v93, v192
    v_sub_f32 v94, v94, v192
    v_sub_f32 v95, v95, v192
    v_sub_f32 v104, v104, v192
    v_sub_f32 v105, v105, v192
    v_sub_f32 v106, v106, v192
    v_sub_f32 v107, v107, v192
    v_sub_f32 v108, v108, v192
    v_sub_f32 v109, v109, v192
    v_sub_f32 v110, v110, v192
    v_sub_f32 v111, v111, v192
    v_exp_f32 v80, v80
    v_exp_f32 v81, v81
    v_exp_f32 v82, v82
    v_exp_f32 v83, v83
    v_exp_f32 v84, v84
    v_exp_f32 v85, v85
    v_exp_f32 v86, v86
    v_exp_f32 v87, v87
    v_exp_f32 v88, v88
    v_exp_f32 v89, v89
    v_exp_f32 v90, v90
    v_exp_f32 v91, v91
    v_exp_f32 v92, v92
    v_exp_f32 v93, v93
    v_exp_f32 v94, v94
    v_exp_f32 v95, v95
    v_exp_f32 v104, v104
    v_exp_f32 v105, v105
    v_exp_f32 v106, v106
    v_exp_f32 v107, v107
    v_exp_f32 v108, v108
    v_exp_f32 v109, v109
    v_exp_f32 v110, v110
    v_exp_f32 v111, v111
    s_nop 1
    v_smfmac_f32_32x32x32_bf16 v[112:127], v[176:179], v[80:87], v44
    v_smfmac_f32_16x16x64_bf16 v[144:147], v[40:43], v[80:87], v44
    v_smfmac_f32_32x32x32_bf16 v[112:127], v[180:183], v[88:95], v44
    v_smfmac_f32_16x16x64_bf16 v[144:147], v[40:43], v[88:95], v44
    v_smfmac_f32_32x32x32_bf16 v[112:127], v[216:219], v[104:111], v44
    v_smfmac_f32_16x16x64_bf16 v[144:147], v[40:43], v[104:111], v44
    s_nop 7
    v_rcp_f32 v194, v144
    s_nop 3
    v_mul_f32 v112, v194, v112
    v_mul_f32 v113, v194, v113
    v_mul_f32 v114, v194, v114
    v_mul_f32 v115, v194, v115
    v_mul_f32 v116, v194, v116
    v_mul_f32 v117, v194, v117
    v_mul_f32 v118, v194, v118
    v_mul_f32 v119, v194, v119
    v_mul_f32 v120, v194, v120
    v_mul_f32 v121, v194, v121
    v_mul_f32 v122, v194, v122
    v_mul_f32 v123, v194, v123
    v_mul_f32 v124, v194, v124
    v_mul_f32 v125, v194, v125
    v_mul_f32 v126, v194, v126
    v_mul_f32 v127, v194, v127
    v_cvt_pk_bf16_f32 v148, v112, v113
    v_cvt_pk_bf16_f32 v149, v114, v115
    v_cvt_pk_bf16_f32 v150, v116, v117
    v_cvt_pk_bf16_f32 v151, v118, v119
    v_cvt_pk_bf16_f32 v152, v120, v121
    v_cvt_pk_bf16_f32 v153, v122, v123
    v_cvt_pk_bf16_f32 v154, v124, v125
    v_cvt_pk_bf16_f32 v155, v126, v127
    buffer_store_dwordx4 v[148:151], v254, s[12:15], s55 offen offset:0 sc1
    buffer_store_dwordx4 v[152:155], v254, s[12:15], s55 offen offset:1024 sc1
    v_mov_b32 v45, v46
    v_add_u32 v46, 65536, v220
    s_mov_b32 s31, 65536
    s_waitcnt vmcnt(6)
    s_barrier
    ds_read_b128 v[176:179], v45 offset:0
    ds_read_b128 v[180:183], v45 offset:1024
    v_mov_b32 v144, 0
    v_mov_b32 v145, 0
    v_mov_b32 v146, 0
    v_mov_b32 v147, 0
    v_mov_b32 v148, 0
    v_mov_b32 v149, 0
    v_mov_b32 v150, 0
    v_mov_b32 v151, 0
    v_mov_b32 v152, 0
    v_mov_b32 v153, 0
    v_mov_b32 v154, 0
    v_mov_b32 v155, 0
    v_mov_b32 v156, 0
    v_mov_b32 v157, 0
    v_mov_b32 v158, 0
    v_mov_b32 v159, 0
    s_waitcnt lgkmcnt(0)
    ds_read_b128 v[160:163], v45 offset:4096
    ds_read_b128 v[164:167], v45 offset:5120
    ds_read_b128 v[168:171], v45 offset:2048
    ds_read_b128 v[172:175], v45 offset:3072
    v_mfma_f32_32x32x16_bf16 v[80:95], v[176:179], v[128:131], v[48:63]
    v_mfma_f32_32x32x16_bf16 v[80:95], v[180:183], v[132:135], v[80:95]
    s_nop 7
    s_nop 3
    v_mfma_f32_32x32x16_bf16 v[112:127], v[176:179], v[136:139], v[64:79]
    v_exp_f32 v80, v80
    v_exp_f32 v81, v81
    v_exp_f32 v82, v82
    v_mfma_f32_32x32x16_bf16 v[112:127], v[180:183], v[140:143], v[112:127]
    v_exp_f32 v83, v83
    v_exp_f32 v84, v84
    v_exp_f32 v85, v85
    v_smfmac_f32_32x32x32_bf16 v[16:31], v[184:187], v[144:151], v44
    v_exp_f32 v86, v86
    v_exp_f32 v87, v87
    v_smfmac_f32_16x16x64_bf16 v[36:39], v[40:43], v[144:151], v44
    v_exp_f32 v88, v88
    v_exp_f32 v89, v89
    v_exp_f32 v90, v90
    v_smfmac_f32_32x32x32_bf16 v[16:31], v[188:191], v[152:159], v44
    v_exp_f32 v91, v91
    v_exp_f32 v92, v92
    v_exp_f32 v93, v93
    v_smfmac_f32_16x16x64_bf16 v[36:39], v[40:43], v[152:159], v44
    v_exp_f32 v94, v94
    v_exp_f32 v95, v95
    s_waitcnt lgkmcnt(0)
    v_mfma_f32_32x32x16_bf16 v[96:111], v[160:163], v[128:131], v[48:63]
    v_exp_f32 v112, v112
    s_add_u32 s61, s50, 0
    s_and_b32 s61, s61, 3
    s_lshl_b32 s61, s61, 18
    s_add_u32 s61, s61, s38
    s_add_u32 m0, s39, 98304
    s_nop 0
    buffer_load_dwordx4 v224, s[4:7], s61 offen lds
    v_exp_f32 v113, v113
    ds_read_b128 v[176:179], v45 offset:8192
    v_exp_f32 v114, v114
    s_add_u32 m0, s39, 99328
    s_nop 0
    buffer_load_dwordx4 v225, s[4:7], s61 offen lds
    v_mfma_f32_32x32x16_bf16 v[96:111], v[164:167], v[132:135], v[96:111]
    v_exp_f32 v115, v115
    ds_read_b128 v[180:183], v45 offset:9216
    v_exp_f32 v116, v116
    v_exp_f32 v117, v117
    ds_read_b128 v[184:187], v45 offset:6144
    v_smfmac_f32_32x32x32_bf16 v[0:15], v[168:171], v[80:87], v44
    v_exp_f32 v118, v118
    v_exp_f32 v119, v119
    ds_read_b128 v[188:191], v45 offset:7168
    v_smfmac_f32_16x16x64_bf16 v[32:35], v[40:43], v[80:87], v44
    v_exp_f32 v120, v120
    v_exp_f32 v121, v121
    v_exp_f32 v122, v122
    v_smfmac_f32_32x32x32_bf16 v[0:15], v[172:175], v[88:95], v44
    v_exp_f32 v123, v123
    v_exp_f32 v124, v124
    v_exp_f32 v125, v125
    v_smfmac_f32_16x16x64_bf16 v[32:35], v[40:43], v[88:95], v44
    v_exp_f32 v126, v126
    v_exp_f32 v127, v127
    v_mfma_f32_32x32x16_bf16 v[144:159], v[160:163], v[136:139], v[64:79]
    v_exp_f32 v96, v96
    v_exp_f32 v97, v97
    v_exp_f32 v98, v98
    v_mfma_f32_32x32x16_bf16 v[144:159], v[164:167], v[140:143], v[144:159]
    v_exp_f32 v99, v99
    v_exp_f32 v100, v100
    v_exp_f32 v101, v101
    v_smfmac_f32_32x32x32_bf16 v[16:31], v[168:171], v[112:119], v44
    v_exp_f32 v102, v102
    v_exp_f32 v103, v103
    v_smfmac_f32_16x16x64_bf16 v[36:39], v[40:43], v[112:119], v44
    v_exp_f32 v104, v104
    v_exp_f32 v105, v105
    v_exp_f32 v106, v106
    v_smfmac_f32_32x32x32_bf16 v[16:31], v[172:175], v[120:127], v44
    v_exp_f32 v107, v107
    v_exp_f32 v108, v108
    v_exp_f32 v109, v109
    v_smfmac_f32_16x16x64_bf16 v[36:39], v[40:43], v[120:127], v44
    v_exp_f32 v110, v110
    v_exp_f32 v111, v111
    s_waitcnt lgkmcnt(0)
    v_mfma_f32_32x32x16_bf16 v[80:95], v[176:179], v[128:131], v[48:63]
    v_exp_f32 v144, v144
    s_add_u32 m0, s39, 106496
    s_nop 0
    buffer_load_dwordx4 v226, s[4:7], s61 offen lds
    v_exp_f32 v145, v145
    ds_read_b128 v[160:163], v45 offset:12288
    v_exp_f32 v146, v146
    s_add_u32 m0, s39, 107520
    s_nop 0
    buffer_load_dwordx4 v227, s[4:7], s61 offen lds
    v_mfma_f32_32x32x16_bf16 v[80:95], v[180:183], v[132:135], v[80:95]
    v_exp_f32 v147, v147
    ds_read_b128 v[164:167], v45 offset:13312
    v_exp_f32 v148, v148
    v_exp_f32 v149, v149
    ds_read_b128 v[168:171], v45 offset:10240
    v_smfmac_f32_32x32x32_bf16 v[0:15], v[184:187], v[96:103], v44
    v_exp_f32 v150, v150
    v_exp_f32 v151, v151
    ds_read_b128 v[172:175], v45 offset:11264
    v_smfmac_f32_16x16x64_bf16 v[32:35], v[40:43], v[96:103], v44
    v_exp_f32 v152, v152
    v_exp_f32 v153, v153
    v_exp_f32 v154, v154
    v_smfmac_f32_32x32x32_bf16 v[0:15], v[188:191], v[104:111], v44
    v_exp_f32 v155, v155
    v_exp_f32 v156, v156
    v_exp_f32 v157, v157
    v_smfmac_f32_16x16x64_bf16 v[32:35], v[40:43], v[104:111], v44
    v_exp_f32 v158, v158
    v_exp_f32 v159, v159
    v_mfma_f32_32x32x16_bf16 v[112:127], v[176:179], v[136:139], v[64:79]
    v_exp_f32 v80, v80
    v_exp_f32 v81, v81
    v_exp_f32 v82, v82
    v_mfma_f32_32x32x16_bf16 v[112:127], v[180:183], v[140:143], v[112:127]
    v_exp_f32 v83, v83
    v_exp_f32 v84, v84
    v_exp_f32 v85, v85
    v_smfmac_f32_32x32x32_bf16 v[16:31], v[184:187], v[144:151], v44
    v_exp_f32 v86, v86
    v_exp_f32 v87, v87
    v_smfmac_f32_16x16x64_bf16 v[36:39], v[40:43], v[144:151], v44
    v_exp_f32 v88, v88
    v_exp_f32 v89, v89
    v_exp_f32 v90, v90
    v_smfmac_f32_32x32x32_bf16 v[16:31], v[188:191], v[152:159], v44
    v_exp_f32 v91, v91
    v_exp_f32 v92, v92
    v_exp_f32 v93, v93
    v_smfmac_f32_16x16x64_bf16 v[36:39], v[40:43], v[152:159], v44
    v_exp_f32 v94, v94
    v_exp_f32 v95, v95
    s_waitcnt vmcnt(4) lgkmcnt(0)
    s_barrier
    s_cmp_lg_u32 s22, 0
    s_cbranch_scc1 L_fs_f2
    v_mov_b32 v207, s26
    v_lshlrev_b32 v206, 2, v255
    buffer_store_dword v207, v206, s[12:15], s44 offen sc1
L_fs_f2:
    v_mfma_f32_32x32x16_bf16 v[96:111], v[160:163], v[128:131], v[48:63]
    v_exp_f32 v112, v112
    s_add_u32 m0, s53, s30
    s_add_u32 s61, s29, s28
    buffer_load_dwordx4 v47, s[12:15], s61 offen sc1 lds
    v_exp_f32 v113, v113
    ds_read_b128 v[184:187], v45 offset:14336
    v_exp_f32 v114, v114
    buffer_load_dwordx4 v47, s[12:15], s61 offen offset:1024 sc1 lds
    v_mfma_f32_32x32x16_bf16 v[96:111], v[164:167], v[132:135], v[96:111]
    v_exp_f32 v115, v115
    ds_read_b128 v[188:191], v45 offset:15360
    v_exp_f32 v116, v116
    buffer_load_dwordx4 v47, s[12:15], s61 offen offset:2048 sc1 lds
    v_exp_f32 v117, v117
    ds_read_b128 v[176:179], v46 offset:0
    v_smfmac_f32_32x32x32_bf16 v[0:15], v[168:171], v[80:87], v44
    v_exp_f32 v118, v118
    buffer_load_dwordx4 v47, s[12:15], s61 offen offset:3072 sc1 lds
    s_add_u32 s28, s28, 32768
    s_and_b32 s28, s28, 262143
    s_add_u32 s30, s30, 32768
    s_cmp_eq_u32 s30, 98304
    s_cselect_b32 s30, 0, s30
    v_exp_f32 v119, v119
    ds_read_b128 v[180:183], v46 offset:1024
    v_smfmac_f32_16x16x64_bf16 v[32:35], v[40:43], v[80:87], v44
    v_exp_f32 v120, v120
    v_exp_f32 v121, v121
    v_exp_f32 v122, v122
    v_smfmac_f32_32x32x32_bf16 v[0:15], v[172:175], v[88:95], v44
    v_exp_f32 v123, v123
    v_exp_f32 v124, v124
    v_exp_f32 v125, v125
    v_smfmac_f32_16x16x64_bf16 v[32:35], v[40:43], v[88:95], v44
    v_exp_f32 v126, v126
    v_exp_f32 v127, v127
    v_mfma_f32_32x32x16_bf16 v[144:159], v[160:163], v[136:139], v[64:79]
    v_exp_f32 v96, v96
    v_exp_f32 v97, v97
    v_exp_f32 v98, v98
    v_mfma_f32_32x32x16_bf16 v[144:159], v[164:167], v[140:143], v[144:159]
    v_exp_f32 v99, v99
    v_exp_f32 v100, v100
    v_exp_f32 v101, v101
    v_smfmac_f32_32x32x32_bf16 v[16:31], v[168:171], v[112:119], v44
    v_exp_f32 v102, v102
    v_exp_f32 v103, v103
    v_smfmac_f32_16x16x64_bf16 v[36:39], v[40:43], v[112:119], v44
    v_exp_f32 v104, v104
    v_exp_f32 v105, v105
    v_exp_f32 v106, v106
    v_smfmac_f32_32x32x32_bf16 v[16:31], v[172:175], v[120:127], v44
    v_exp_f32 v107, v107
    v_exp_f32 v108, v108
    v_exp_f32 v109, v109
    v_smfmac_f32_16x16x64_bf16 v[36:39], v[40:43], v[120:127], v44
    v_exp_f32 v110, v110
    v_exp_f32 v111, v111
    s_waitcnt lgkmcnt(0)
    v_mfma_f32_32x32x16_bf16 v[80:95], v[176:179], v[128:131], v[48:63]
    v_exp_f32 v144, v144
    s_add_u32 s61, s50, 1
    s_and_b32 s61, s61, 3
    s_lshl_b32 s61, s61, 18
    s_add_u32 s61, s61, s38
    s_add_u32 m0, s39, 131072
    s_nop 0
    buffer_load_dwordx4 v224, s[4:7], s61 offen lds
    v_exp_f32 v145, v145
    ds_read_b128 v[160:163], v46 offset:4096
    v_exp_f32 v146, v146
    s_add_u32 m0, s39, 132096
    s_nop 0
    buffer_load_dwordx4 v225, s[4:7], s61 offen lds
    v_mfma_f32_32x32x16_bf16 v[80:95], v[180:183], v[132:135], v[80:95]
    v_exp_f32 v147, v147
    ds_read_b128 v[164:167], v46 offset:5120
    v_exp_f32 v148, v148
    s_add_u32 m0, s39, 139264
    s_nop 0
    buffer_load_dwordx4 v226, s[4:7], s61 offen lds
    v_exp_f32 v149, v149
    ds_read_b128 v[168:171], v46 offset:2048
    v_smfmac_f32_32x32x32_bf16 v[0:15], v[184:187], v[96:103], v44
    v_exp_f32 v150, v150
    s_add_u32 m0, s39, 140288
    s_nop 0
    buffer_load_dwordx4 v227, s[4:7], s61 offen lds
    v_exp_f32 v151, v151
    ds_read_b128 v[172:175], v46 offset:3072
    v_smfmac_f32_16x16x64_bf16 v[32:35], v[40:43], v[96:103], v44
    v_exp_f32 v152, v152
    v_exp_f32 v153, v153
    v_exp_f32 v154, v154
    v_smfmac_f32_32x32x32_bf16 v[0:15], v[188:191], v[104:111], v44
    v_exp_f32 v155, v155
    v_exp_f32 v156, v156
    v_exp_f32 v157, v157
    v_smfmac_f32_16x16x64_bf16 v[32:35], v[40:43], v[104:111], v44
    v_exp_f32 v158, v158
    v_exp_f32 v159, v159
    v_mov_b32 v45, v46
    s_add_u32 s31, s31, 32768
    s_cmp_eq_u32 s31, 98304
    s_cselect_b32 s31, 0, s31
    v_add_u32 v46, s31, v220
    s_mov_b32 s52, 4
L_at_loop:
    v_mfma_f32_32x32x16_bf16 v[112:127], v[176:179], v[136:139], v[64:79]
    v_exp_f32 v80, v80
    v_exp_f32 v81, v81
    v_exp_f32 v82, v82
    v_mfma_f32_32x32x16_bf16 v[112:127], v[180:183], v[140:143], v[112:127]
    v_exp_f32 v83, v83
    v_exp_f32 v84, v84
    v_exp_f32 v85, v85
    v_smfmac_f32_32x32x32_bf16 v[16:31], v[184:187], v[144:151], v44
    v_exp_f32 v86, v86
    v_exp_f32 v87, v87
    v_smfmac_f32_16x16x64_bf16 v[36:39], v[40:43], v[144:151], v44
    v_exp_f32 v88, v88
    v_exp_f32 v89, v89
    v_exp_f32 v90, v90
    v_smfmac_f32_32x32x32_bf16 v[16:31], v[188:191], v[152:159], v44
    v_exp_f32 v91, v91
    v_exp_f32 v92, v92
    v_exp_f32 v93, v93
    v_smfmac_f32_16x16x64_bf16 v[36:39], v[40:43], v[152:159], v44
    v_exp_f32 v94, v94
    v_exp_f32 v95, v95
    s_waitcnt lgkmcnt(0)
    v_mfma_f32_32x32x16_bf16 v[96:111], v[160:163], v[128:131], v[48:63]
    v_exp_f32 v112, v112
    v_exp_f32 v113, v113
    ds_read_b128 v[176:179], v45 offset:8192
    v_exp_f32 v114, v114
    v_mfma_f32_32x32x16_bf16 v[96:111], v[164:167], v[132:135], v[96:111]
    v_exp_f32 v115, v115
    ds_read_b128 v[180:183], v45 offset:9216
    v_exp_f32 v116, v116
    v_exp_f32 v117, v117
    ds_read_b128 v[184:187], v45 offset:6144
    v_smfmac_f32_32x32x32_bf16 v[0:15], v[168:171], v[80:87], v44
    v_exp_f32 v118, v118
    v_exp_f32 v119, v119
    ds_read_b128 v[188:191], v45 offset:7168
    v_smfmac_f32_16x16x64_bf16 v[32:35], v[40:43], v[80:87], v44
    v_exp_f32 v120, v120
    v_exp_f32 v121, v121
    v_exp_f32 v122, v122
    v_smfmac_f32_32x32x32_bf16 v[0:15], v[172:175], v[88:95], v44
    v_exp_f32 v123, v123
    v_exp_f32 v124, v124
    v_exp_f32 v125, v125
    v_smfmac_f32_16x16x64_bf16 v[32:35], v[40:43], v[88:95], v44
    v_exp_f32 v126, v126
    v_exp_f32 v127, v127
    v_mfma_f32_32x32x16_bf16 v[144:159], v[160:163], v[136:139], v[64:79]
    v_exp_f32 v96, v96
    v_exp_f32 v97, v97
    v_exp_f32 v98, v98
    v_mfma_f32_32x32x16_bf16 v[144:159], v[164:167], v[140:143], v[144:159]
    v_exp_f32 v99, v99
    v_exp_f32 v100, v100
    v_exp_f32 v101, v101
    v_smfmac_f32_32x32x32_bf16 v[16:31], v[168:171], v[112:119], v44
    v_exp_f32 v102, v102
    v_exp_f32 v103, v103
    v_smfmac_f32_16x16x64_bf16 v[36:39], v[40:43], v[112:119], v44
    v_exp_f32 v104, v104
    v_exp_f32 v105, v105
    v_exp_f32 v106, v106
    v_smfmac_f32_32x32x32_bf16 v[16:31], v[172:175], v[120:127], v44
    v_exp_f32 v107, v107
    v_exp_f32 v108, v108
    v_exp_f32 v109, v109
    v_smfmac_f32_16x16x64_bf16 v[36:39], v[40:43], v[120:127], v44
    v_exp_f32 v110, v110
    v_exp_f32 v111, v111
    s_waitcnt lgkmcnt(0)
    v_mfma_f32_32x32x16_bf16 v[80:95], v[176:179], v[128:131], v[48:63]
    v_exp_f32 v144, v144
    v_exp_f32 v145, v145
    ds_read_b128 v[160:163], v45 offset:12288
    v_exp_f32 v146, v146
    v_mfma_f32_32x32x16_bf16 v[80:95], v[180:183], v[132:135], v[80:95]
    v_exp_f32 v147, v147
    ds_read_b128 v[164:167], v45 offset:13312
    v_exp_f32 v148, v148
    v_exp_f32 v149, v149
    ds_read_b128 v[168:171], v45 offset:10240
    v_smfmac_f32_32x32x32_bf16 v[0:15], v[184:187], v[96:103], v44
    v_exp_f32 v150, v150
    v_exp_f32 v151, v151
    ds_read_b128 v[172:175], v45 offset:11264
    v_smfmac_f32_16x16x64_bf16 v[32:35], v[40:43], v[96:103], v44
    v_exp_f32 v152, v152
    v_exp_f32 v153, v153
    v_exp_f32 v154, v154
    v_smfmac_f32_32x32x32_bf16 v[0:15], v[188:191], v[104:111], v44
    v_exp_f32 v155, v155
    v_exp_f32 v156, v156
    v_exp_f32 v157, v157
    v_smfmac_f32_16x16x64_bf16 v[32:35], v[40:43], v[104:111], v44
    v_exp_f32 v158, v158
    v_exp_f32 v159, v159
    v_mfma_f32_32x32x16_bf16 v[112:127], v[176:179], v[136:139], v[64:79]
    v_exp_f32 v80, v80
    v_exp_f32 v81, v81
    v_exp_f32 v82, v82
    v_mfma_f32_32x32x16_bf16 v[112:127], v[180:183], v[140:143], v[112:127]
    v_exp_f32 v83, v83
    v_exp_f32 v84, v84
    v_exp_f32 v85, v85
    v_smfmac_f32_32x32x32_bf16 v[16:31], v[184:187], v[144:151], v44
    v_exp_f32 v86, v86
    v_exp_f32 v87, v87
    v_smfmac_f32_16x16x64_bf16 v[36:39], v[40:43], v[144:151], v44
    v_exp_f32 v88, v88
    v_exp_f32 v89, v89
    v_exp_f32 v90, v90
    v_smfmac_f32_32x32x32_bf16 v[16:31], v[188:191], v[152:159], v44
    v_exp_f32 v91, v91
    v_exp_f32 v92, v92
    v_exp_f32 v93, v93
    v_smfmac_f32_16x16x64_bf16 v[36:39], v[40:43], v[152:159], v44
    v_exp_f32 v94, v94
    v_exp_f32 v95, v95
    s_waitcnt vmcnt(0) lgkmcnt(0)
    s_barrier
    v_mfma_f32_32x32x16_bf16 v[96:111], v[160:163], v[128:131], v[48:63]
    v_exp_f32 v112, v112
    s_add_u32 m0, s53, s30
    s_add_u32 s61, s29, s28
    buffer_load_dwordx4 v47, s[12:15], s61 offen sc1 lds
    v_exp_f32 v113, v113
    ds_read_b128 v[184:187], v45 offset:14336
    v_exp_f32 v114, v114
    buffer_load_dwordx4 v47, s[12:15], s61 offen offset:1024 sc1 lds
    v_mfma_f32_32x32x16_bf16 v[96:111], v[164:167], v[132:135], v[96:111]
    v_exp_f32 v115, v115
    ds_read_b128 v[188:191], v45 offset:15360
    v_exp_f32 v116, v116
    v_exp_f32 v117, v117
    ds_read_b128 v[176:179], v46 offset:0
    v_smfmac_f32_32x32x32_bf16 v[0:15], v[168:171], v[80:87], v44
    v_exp_f32 v118, v118
    v_exp_f32 v119, v119
    ds_read_b128 v[180:183], v46 offset:1024
    v_smfmac_f32_16x16x64_bf16 v[32:35], v[40:43], v[80:87], v44
    v_exp_f32 v120, v120
    v_exp_f32 v121, v121
    v_exp_f32 v122, v122
    v_smfmac_f32_32x32x32_bf16 v[0:15], v[172:175], v[88:95], v44
    v_exp_f32 v123, v123
    v_exp_f32 v124, v124
    v_exp_f32 v125, v125
    v_smfmac_f32_16x16x64_bf16 v[32:35], v[40:43], v[88:95], v44
    v_exp_f32 v126, v126
    v_exp_f32 v127, v127
    v_mfma_f32_32x32x16_bf16 v[144:159], v[160:163], v[136:139], v[64:79]
    v_exp_f32 v96, v96
    v_exp_f32 v97, v97
    v_exp_f32 v98, v98
    v_mfma_f32_32x32x16_bf16 v[144:159], v[164:167], v[140:143], v[144:159]
    v_exp_f32 v99, v99
    v_exp_f32 v100, v100
    v_exp_f32 v101, v101
    v_smfmac_f32_32x32x32_bf16 v[16:31], v[168:171], v[112:119], v44
    v_exp_f32 v102, v102
    v_exp_f32 v103, v103
    v_smfmac_f32_16x16x64_bf16 v[36:39], v[40:43], v[112:119], v44
    v_exp_f32 v104, v104
    v_exp_f32 v105, v105
    v_exp_f32 v106, v106
    v_smfmac_f32_32x32x32_bf16 v[16:31], v[172:175], v[120:127], v44
    v_exp_f32 v107, v107
    v_exp_f32 v108, v108
    v_exp_f32 v109, v109
    v_smfmac_f32_16x16x64_bf16 v[36:39], v[40:43], v[120:127], v44
    v_exp_f32 v110, v110
    v_exp_f32 v111, v111
    s_waitcnt lgkmcnt(0)
    v_mfma_f32_32x32x16_bf16 v[80:95], v[176:179], v[128:131], v[48:63]
    v_exp_f32 v144, v144
    buffer_load_dwordx4 v47, s[12:15], s61 offen offset:2048 sc1 lds
    v_exp_f32 v145, v145
    ds_read_b128 v[160:163], v46 offset:4096
    v_exp_f32 v146, v146
    buffer_load_dwordx4 v47, s[12:15], s61 offen offset:3072 sc1 lds
    s_add_u32 s28, s28, 32768
    s_and_b32 s28, s28, 262143
    s_add_u32 s30, s30, 32768
    s_cmp_eq_u32 s30, 98304
    s_cselect_b32 s30, 0, s30
    v_mfma_f32_32x32x16_bf16 v[80:95], v[180:183], v[132:135], v[80:95]
    v_exp_f32 v147, v147
    ds_read_b128 v[164:167], v46 offset:5120
    v_exp_f32 v148, v148
    v_exp_f32 v149, v149
    ds_read_b128 v[168:171], v46 offset:2048
    v_smfmac_f32_32x32x32_bf16 v[0:15], v[184:187], v[96:103], v44
    v_exp_f32 v150, v150
    v_exp_f32 v151, v151
    ds_read_b128 v[172:175], v46 offset:3072
    v_smfmac_f32_16x16x64_bf16 v[32:35], v[40:43], v[96:103], v44
    v_exp_f32 v152, v152
    v_exp_f32 v153, v153
    v_exp_f32 v154, v154
    v_smfmac_f32_32x32x32_bf16 v[0:15], v[188:191], v[104:111], v44
    v_exp_f32 v155, v155
    v_exp_f32 v156, v156
    v_exp_f32 v157, v157
    v_smfmac_f32_16x16x64_bf16 v[32:35], v[40:43], v[104:111], v44
    v_exp_f32 v158, v158
    v_exp_f32 v159, v159
    v_mov_b32 v45, v46
    s_add_u32 s31, s31, 32768
    s_cmp_eq_u32 s31, 98304
    s_cselect_b32 s31, 0, s31
    v_add_u32 v46, s31, v220
    s_sub_u32 s52, s52, 1
    s_cmp_lg_u32 s52, 0
    s_cbranch_scc1 L_at_loop
    buffer_load_dword v221, v234, s[12:15], s40 offen sc1
    v_mfma_f32_32x32x16_bf16 v[112:127], v[176:179], v[136:139], v[64:79]
    v_exp_f32 v80, v80
    v_exp_f32 v81, v81
    v_exp_f32 v82, v82
    v_mfma_f32_32x32x16_bf16 v[112:127], v[180:183], v[140:143], v[112:127]
    v_exp_f32 v83, v83
    v_exp_f32 v84, v84
    v_exp_f32 v85, v85
    v_smfmac_f32_32x32x32_bf16 v[16:31], v[184:187], v[144:151], v44
    v_exp_f32 v86, v86
    v_exp_f32 v87, v87
    v_smfmac_f32_16x16x64_bf16 v[36:39], v[40:43], v[144:151], v44
    v_exp_f32 v88, v88
    v_exp_f32 v89, v89
    v_exp_f32 v90, v90
    v_smfmac_f32_32x32x32_bf16 v[16:31], v[188:191], v[152:159], v44
    v_exp_f32 v91, v91
    v_exp_f32 v92, v92
    v_exp_f32 v93, v93
    v_smfmac_f32_16x16x64_bf16 v[36:39], v[40:43], v[152:159], v44
    v_exp_f32 v94, v94
    v_exp_f32 v95, v95
    s_waitcnt lgkmcnt(0)
    v_mfma_f32_32x32x16_bf16 v[96:111], v[160:163], v[128:131], v[48:63]
    v_exp_f32 v112, v112
    s_lshr_b32 s64, s2, 7
    s_cmp_eq_u32 s64, 0
    s_cselect_b32 s64, s4, s8
    s_cselect_b32 s65, s5, s9
    s_mov_b32 s66, s6
    s_mov_b32 s67, s7
    buffer_load_dword v232, v230, s[64:67], 0 offen
    v_exp_f32 v113, v113
    ds_read_b128 v[176:179], v45 offset:8192
    v_exp_f32 v114, v114
    v_mfma_f32_32x32x16_bf16 v[96:111], v[164:167], v[132:135], v[96:111]
    v_exp_f32 v115, v115
    ds_read_b128 v[180:183], v45 offset:9216
    v_exp_f32 v116, v116
    v_exp_f32 v117, v117
    ds_read_b128 v[184:187], v45 offset:6144
    v_smfmac_f32_32x32x32_bf16 v[0:15], v[168:171], v[80:87], v44
    v_exp_f32 v118, v118
    v_exp_f32 v119, v119
    ds_read_b128 v[188:191], v45 offset:7168
    v_smfmac_f32_16x16x64_bf16 v[32:35], v[40:43], v[80:87], v44
    v_exp_f32 v120, v120
    v_exp_f32 v121, v121
    v_exp_f32 v122, v122
    v_smfmac_f32_32x32x32_bf16 v[0:15], v[172:175], v[88:95], v44
    v_exp_f32 v123, v123
    v_exp_f32 v124, v124
    v_exp_f32 v125, v125
    v_smfmac_f32_16x16x64_bf16 v[32:35], v[40:43], v[88:95], v44
    v_exp_f32 v126, v126
    v_exp_f32 v127, v127
    v_mfma_f32_32x32x16_bf16 v[144:159], v[160:163], v[136:139], v[64:79]
    v_exp_f32 v96, v96
    v_exp_f32 v97, v97
    v_exp_f32 v98, v98
    v_mfma_f32_32x32x16_bf16 v[144:159], v[164:167], v[140:143], v[144:159]
    v_exp_f32 v99, v99
    v_exp_f32 v100, v100
    v_exp_f32 v101, v101
    v_smfmac_f32_32x32x32_bf16 v[16:31], v[168:171], v[112:119], v44
    v_exp_f32 v102, v102
    v_exp_f32 v103, v103
    v_smfmac_f32_16x16x64_bf16 v[36:39], v[40:43], v[112:119], v44
    v_exp_f32 v104, v104
    v_exp_f32 v105, v105
    v_exp_f32 v106, v106
    v_smfmac_f32_32x32x32_bf16 v[16:31], v[172:175], v[120:127], v44
    v_exp_f32 v107, v107
    v_exp_f32 v108, v108
    v_exp_f32 v109, v109
    v_smfmac_f32_16x16x64_bf16 v[36:39], v[40:43], v[120:127], v44
    v_exp_f32 v110, v110
    v_exp_f32 v111, v111
    s_waitcnt lgkmcnt(0)
    v_mfma_f32_32x32x16_bf16 v[80:95], v[176:179], v[128:131], v[48:63]
    v_exp_f32 v144, v144
    v_exp_f32 v145, v145
    ds_read_b128 v[160:163], v45 offset:12288
    v_exp_f32 v146, v146
    v_mfma_f32_32x32x16_bf16 v[80:95], v[180:183], v[132:135], v[80:95]
    v_exp_f32 v147, v147
    ds_read_b128 v[164:167], v45 offset:13312
    v_exp_f32 v148, v148
    v_exp_f32 v149, v149
    ds_read_b128 v[168:171], v45 offset:10240
    v_smfmac_f32_32x32x32_bf16 v[0:15], v[184:187], v[96:103], v44
    v_exp_f32 v150, v150
    v_exp_f32 v151, v151
    ds_read_b128 v[172:175], v45 offset:11264
    v_smfmac_f32_16x16x64_bf16 v[32:35], v[40:43], v[96:103], v44
    v_exp_f32 v152, v152
    v_exp_f32 v153, v153
    v_exp_f32 v154, v154
    v_smfmac_f32_32x32x32_bf16 v[0:15], v[188:191], v[104:111], v44
    v_exp_f32 v155, v155
    v_exp_f32 v156, v156
    v_exp_f32 v157, v157
    v_smfmac_f32_16x16x64_bf16 v[32:35], v[40:43], v[104:111], v44
    v_exp_f32 v158, v158
    v_exp_f32 v159, v159
    v_mfma_f32_32x32x16_bf16 v[112:127], v[176:179], v[136:139], v[64:79]
    v_exp_f32 v80, v80
    v_exp_f32 v81, v81
    v_exp_f32 v82, v82
    v_mfma_f32_32x32x16_bf16 v[112:127], v[180:183], v[140:143], v[112:127]
    v_exp_f32 v83, v83
    v_exp_f32 v84, v84
    v_exp_f32 v85, v85
    v_smfmac_f32_32x32x32_bf16 v[16:31], v[184:187], v[144:151], v44
    v_exp_f32 v86, v86
    v_exp_f32 v87, v87
    v_smfmac_f32_16x16x64_bf16 v[36:39], v[40:43], v[144:151], v44
    v_exp_f32 v88, v88
    v_exp_f32 v89, v89
    v_exp_f32 v90, v90
    v_smfmac_f32_32x32x32_bf16 v[16:31], v[188:191], v[152:159], v44
    v_exp_f32 v91, v91
    v_exp_f32 v92, v92
    v_exp_f32 v93, v93
    v_smfmac_f32_16x16x64_bf16 v[36:39], v[40:43], v[152:159], v44
    v_exp_f32 v94, v94
    v_exp_f32 v95, v95
    s_waitcnt vmcnt(1) lgkmcnt(0)
    s_barrier
    s_mov_b32 s60, 32768
    s_waitcnt vmcnt(63)
    s_branch L_poll_f2_chk
L_poll_f2:
    s_waitcnt vmcnt(0)
L_poll_f2_chk:
    v_cmp_ne_u32 vcc, s26, v221
    s_nop 4
    s_cbranch_vccz L_poll_f2_ok
    s_sub_u32 s60, s60, 1
    s_cmp_eq_u32 s60, 0
    s_cbranch_scc1 L_poll_f2_ok
    s_sleep 2
    buffer_load_dword v221, v234, s[12:15], s40 offen sc1
    s_branch L_poll_f2
L_poll_f2_ok:
    v_mfma_f32_32x32x16_bf16 v[96:111], v[160:163], v[128:131], v[48:63]
    v_exp_f32 v112, v112
    v_exp_f32 v113, v113
    ds_read_b128 v[184:187], v45 offset:14336
    v_exp_f32 v114, v114
    v_mfma_f32_32x32x16_bf16 v[96:111], v[164:167], v[132:135], v[96:111]
    v_exp_f32 v115, v115
    ds_read_b128 v[188:191], v45 offset:15360
    v_exp_f32 v116, v116
    v_exp_f32 v117, v117
    ds_read_b128 v[176:179], v46 offset:0
    v_smfmac_f32_32x32x32_bf16 v[0:15], v[168:171], v[80:87], v44
    v_exp_f32 v118, v118
    v_exp_f32 v119, v119
    ds_read_b128 v[180:183], v46 offset:1024
    v_smfmac_f32_16x16x64_bf16 v[32:35], v[40:43], v[80:87], v44
    v_exp_f32 v120, v120
    v_exp_f32 v121, v121
    v_exp_f32 v122, v122
    v_smfmac_f32_32x32x32_bf16 v[0:15], v[172:175], v[88:95], v44
    v_exp_f32 v123, v123
    v_exp_f32 v124, v124
    v_exp_f32 v125, v125
    v_smfmac_f32_16x16x64_bf16 v[32:35], v[40:43], v[88:95], v44
    v_exp_f32 v126, v126
    v_exp_f32 v127, v127
    v_mfma_f32_32x32x16_bf16 v[144:159], v[160:163], v[136:139], v[64:79]
    v_exp_f32 v96, v96
    v_exp_f32 v97, v97
    v_exp_f32 v98, v98
    v_mfma_f32_32x32x16_bf16 v[144:159], v[164:167], v[140:143], v[144:159]
    v_exp_f32 v99, v99
    v_exp_f32 v100, v100
    v_exp_f32 v101, v101
    v_smfmac_f32_32x32x32_bf16 v[16:31], v[168:171], v[112:119], v44
    v_exp_f32 v102, v102
    v_exp_f32 v103, v103
    v_smfmac_f32_16x16x64_bf16 v[36:39], v[40:43], v[112:119], v44
    v_exp_f32 v104, v104
    v_exp_f32 v105, v105
    v_exp_f32 v106, v106
    v_smfmac_f32_32x32x32_bf16 v[16:31], v[172:175], v[120:127], v44
    v_exp_f32 v107, v107
    v_exp_f32 v108, v108
    v_exp_f32 v109, v109
    v_smfmac_f32_16x16x64_bf16 v[36:39], v[40:43], v[120:127], v44
    v_exp_f32 v110, v110
    v_exp_f32 v111, v111
    s_waitcnt lgkmcnt(0)
    v_mfma_f32_32x32x16_bf16 v[80:95], v[176:179], v[128:131], v[48:63]
    v_exp_f32 v144, v144
    s_add_u32 s61, s50, 2
    s_and_b32 s61, s61, 3
    s_lshl_b32 s61, s61, 18
    s_add_u32 s61, s61, s38
    s_add_u32 m0, s39, 65536
    s_nop 0
    buffer_load_dwordx4 v224, s[4:7], s61 offen lds
    v_exp_f32 v145, v145
    ds_read_b128 v[160:163], v46 offset:4096
    v_exp_f32 v146, v146
    s_add_u32 m0, s39, 66560
    s_nop 0
    buffer_load_dwordx4 v225, s[4:7], s61 offen lds
    v_mfma_f32_32x32x16_bf16 v[80:95], v[180:183], v[132:135], v[80:95]
    v_exp_f32 v147, v147
    ds_read_b128 v[164:167], v46 offset:5120
    v_exp_f32 v148, v148
    s_add_u32 m0, s39, 73728
    s_nop 0
    buffer_load_dwordx4 v226, s[4:7], s61 offen lds
    v_exp_f32 v149, v149
    ds_read_b128 v[168:171], v46 offset:2048
    v_smfmac_f32_32x32x32_bf16 v[0:15], v[184:187], v[96:103], v44
    v_exp_f32 v150, v150
    s_add_u32 m0, s39, 74752
    s_nop 0
    buffer_load_dwordx4 v227, s[4:7], s61 offen lds
    v_exp_f32 v151, v151
    ds_read_b128 v[172:175], v46 offset:3072
    v_smfmac_f32_16x16x64_bf16 v[32:35], v[40:43], v[96:103], v44
    v_exp_f32 v152, v152
    v_exp_f32 v153, v153
    v_exp_f32 v154, v154
    v_smfmac_f32_32x32x32_bf16 v[0:15], v[188:191], v[104:111], v44
    v_exp_f32 v155, v155
    v_exp_f32 v156, v156
    v_exp_f32 v157, v157
    v_smfmac_f32_16x16x64_bf16 v[32:35], v[40:43], v[104:111], v44
    v_exp_f32 v158, v158
    v_exp_f32 v159, v159
    v_mov_b32 v45, v46
    s_add_u32 s31, s31, 32768
    s_cmp_eq_u32 s31, 98304
    s_cselect_b32 s31, 0, s31
    v_add_u32 v46, s31, v220
    v_mfma_f32_32x32x16_bf16 v[112:127], v[176:179], v[136:139], v[64:79]
    v_exp_f32 v80, v80
    v_exp_f32 v81, v81
    v_exp_f32 v82, v82
    v_mfma_f32_32x32x16_bf16 v[112:127], v[180:183], v[140:143], v[112:127]
    v_exp_f32 v83, v83
    v_exp_f32 v84, v84
    v_exp_f32 v85, v85
    v_smfmac_f32_32x32x32_bf16 v[16:31], v[184:187], v[144:151], v44
    v_exp_f32 v86, v86
    v_exp_f32 v87, v87
    v_smfmac_f32_16x16x64_bf16 v[36:39], v[40:43], v[144:151], v44
    v_exp_f32 v88, v88
    v_exp_f32 v89, v89
    v_exp_f32 v90, v90
    v_smfmac_f32_32x32x32_bf16 v[16:31], v[188:191], v[152:159], v44
    v_exp_f32 v91, v91
    v_exp_f32 v92, v92
    v_exp_f32 v93, v93
    v_smfmac_f32_16x16x64_bf16 v[36:39], v[40:43], v[152:159], v44
    v_exp_f32 v94, v94
    v_exp_f32 v95, v95
    s_waitcnt lgkmcnt(0)
    v_mfma_f32_32x32x16_bf16 v[96:111], v[160:163], v[128:131], v[48:63]
    v_exp_f32 v112, v112
    s_add_u32 s69, s50, 0
    s_and_b32 s69, s69, 3
    s_lshl_b32 s69, s69, 13
    s_add_u32 s69, s69, s34
    buffer_load_dwordx4 v[236:239], v254, s[12:15], s69 offen offset:0 sc1
    v_exp_f32 v113, v113
    ds_read_b128 v[176:179], v45 offset:8192
    v_exp_f32 v114, v114
    buffer_load_dwordx4 v[240:243], v254, s[12:15], s69 offen offset:1024 sc1
    v_mfma_f32_32x32x16_bf16 v[96:111], v[164:167], v[132:135], v[96:111]
    v_exp_f32 v115, v115
    ds_read_b128 v[180:183], v45 offset:9216
    v_exp_f32 v116, v116
    buffer_load_dwordx4 v[244:247], v254, s[12:15], s69 offen offset:2048 sc1
    v_exp_f32 v117, v117
    ds_read_b128 v[184:187], v45 offset:6144
    v_smfmac_f32_32x32x32_bf16 v[0:15], v[168:171], v[80:87], v44
    v_exp_f32 v118, v118
    buffer_load_dwordx4 v[248:251], v254, s[12:15], s69 offen offset:3072 sc1
    v_exp_f32 v119, v119
    ds_read_b128 v[188:191], v45 offset:7168
    v_smfmac_f32_16x16x64_bf16 v[32:35], v[40:43], v[80:87], v44
    v_exp_f32 v120, v120
    v_exp_f32 v121, v121
    v_exp_f32 v122, v122
    v_smfmac_f32_32x32x32_bf16 v[0:15], v[172:175], v[88:95], v44
    v_exp_f32 v123, v123
    v_exp_f32 v124, v124
    v_exp_f32 v125, v125
    v_smfmac_f32_16x16x64_bf16 v[32:35], v[40:43], v[88:95], v44
    v_exp_f32 v126, v126
    v_exp_f32 v127, v127
    v_mfma_f32_32x32x16_bf16 v[144:159], v[160:163], v[136:139], v[64:79]
    v_exp_f32 v96, v96
    v_exp_f32 v97, v97
    v_exp_f32 v98, v98
    v_mfma_f32_32x32x16_bf16 v[144:159], v[164:167], v[140:143], v[144:159]
    v_exp_f32 v99, v99
    v_exp_f32 v100, v100
    v_exp_f32 v101, v101
    v_smfmac_f32_32x32x32_bf16 v[16:31], v[168:171], v[112:119], v44
    v_exp_f32 v102, v102
    v_exp_f32 v103, v103
    v_smfmac_f32_16x16x64_bf16 v[36:39], v[40:43], v[112:119], v44
    v_exp_f32 v104, v104
    v_exp_f32 v105, v105
    v_exp_f32 v106, v106
    v_smfmac_f32_32x32x32_bf16 v[16:31], v[172:175], v[120:127], v44
    v_exp_f32 v107, v107
    v_exp_f32 v108, v108
    v_exp_f32 v109, v109
    v_smfmac_f32_16x16x64_bf16 v[36:39], v[40:43], v[120:127], v44
    v_exp_f32 v110, v110
    v_exp_f32 v111, v111
    s_waitcnt lgkmcnt(0)
    v_mfma_f32_32x32x16_bf16 v[80:95], v[176:179], v[128:131], v[48:63]
    v_exp_f32 v144, v144
    s_add_u32 s69, s69, 4096
    buffer_load_dwordx4 v[208:211], v254, s[12:15], s69 offen offset:0 sc1
    v_exp_f32 v145, v145
    ds_read_b128 v[160:163], v45 offset:12288
    v_exp_f32 v146, v146
    buffer_load_dwordx4 v[212:215], v254, s[12:15], s69 offen offset:1024 sc1
    v_mfma_f32_32x32x16_bf16 v[80:95], v[180:183], v[132:135], v[80:95]
    v_exp_f32 v147, v147
    ds_read_b128 v[164:167], v45 offset:13312
    v_exp_f32 v148, v148
    buffer_load_dwordx4 v[216:219], v254, s[12:15], s69 offen offset:2048 sc1
    v_exp_f32 v149, v149
    ds_read_b128 v[168:171], v45 offset:10240
    v_smfmac_f32_32x32x32_bf16 v[0:15], v[184:187], v[96:103], v44
    v_exp_f32 v150, v150
    buffer_load_dword v231, v233, s[12:15], s48 offen sc1
    v_exp_f32 v151, v151
    ds_read_b128 v[172:175], v45 offset:11264
    v_smfmac_f32_16x16x64_bf16 v[32:35], v[40:43], v[96:103], v44
    v_exp_f32 v152, v152
    v_exp_f32 v153, v153
    v_exp_f32 v154, v154
    v_smfmac_f32_32x32x32_bf16 v[0:15], v[188:191], v[104:111], v44
    v_exp_f32 v155, v155
    v_exp_f32 v156, v156
    v_exp_f32 v157, v157
    v_smfmac_f32_16x16x64_bf16 v[32:35], v[40:43], v[104:111], v44
    v_exp_f32 v158, v158
    v_exp_f32 v159, v159
    v_mfma_f32_32x32x16_bf16 v[112:127], v[176:179], v[136:139], v[64:79]
    v_exp_f32 v80, v80
    v_exp_f32 v81, v81
    v_exp_f32 v82, v82
    v_mfma_f32_32x32x16_bf16 v[112:127], v[180:183], v[140:143], v[112:127]
    v_exp_f32 v83, v83
    v_exp_f32 v84, v84
    v_exp_f32 v85, v85
    v_smfmac_f32_32x32x32_bf16 v[16:31], v[184:187], v[144:151], v44
    v_exp_f32 v86, v86
    v_exp_f32 v87, v87
    v_smfmac_f32_16x16x64_bf16 v[36:39], v[40:43], v[144:151], v44
    v_exp_f32 v88, v88
    v_exp_f32 v89, v89
    v_exp_f32 v90, v90
    v_smfmac_f32_32x32x32_bf16 v[16:31], v[188:191], v[152:159], v44
    v_exp_f32 v91, v91
    v_exp_f32 v92, v92
    v_exp_f32 v93, v93
    v_smfmac_f32_16x16x64_bf16 v[36:39], v[40:43], v[152:159], v44
    v_exp_f32 v94, v94
    v_exp_f32 v95, v95
    s_waitcnt lgkmcnt(0)
    s_barrier
    v_mfma_f32_32x32x16_bf16 v[96:111], v[160:163], v[128:131], v[48:63]
    v_exp_f32 v112, v112
    v_exp_f32 v113, v113
    ds_read_b128 v[184:187], v45 offset:14336
    v_exp_f32 v114, v114
    v_mfma_f32_32x32x16_bf16 v[96:111], v[164:167], v[132:135], v[96:111]
    v_exp_f32 v115, v115
    ds_read_b128 v[188:191], v45 offset:15360
    v_exp_f32 v116, v116
    v_exp_f32 v117, v117
    v_smfmac_f32_32x32x32_bf16 v[0:15], v[168:171], v[80:87], v44
    v_exp_f32 v118, v118
    v_exp_f32 v119, v119
    v_smfmac_f32_16x16x64_bf16 v[32:35], v[40:43], v[80:87], v44
    v_exp_f32 v120, v120
    v_exp_f32 v121, v121
    v_exp_f32 v122, v122
    v_smfmac_f32_32x32x32_bf16 v[0:15], v[172:175], v[88:95], v44
    v_exp_f32 v123, v123
    v_exp_f32 v124, v124
    v_exp_f32 v125, v125
    v_smfmac_f32_16x16x64_bf16 v[32:35], v[40:43], v[88:95], v44
    v_exp_f32 v126, v126
    v_exp_f32 v127, v127
    v_mfma_f32_32x32x16_bf16 v[144:159], v[160:163], v[136:139], v[64:79]
    v_exp_f32 v96, v96
    v_exp_f32 v97, v97
    v_exp_f32 v98, v98
    v_mfma_f32_32x32x16_bf16 v[144:159], v[164:167], v[140:143], v[144:159]
    v_exp_f32 v99, v99
    v_exp_f32 v100, v100
    v_exp_f32 v101, v101
    v_smfmac_f32_32x32x32_bf16 v[16:31], v[168:171], v[112:119], v44
    v_exp_f32 v102, v102
    v_exp_f32 v103, v103
    v_smfmac_f32_16x16x64_bf16 v[36:39], v[40:43], v[112:119], v44
    v_exp_f32 v104, v104
    v_exp_f32 v105, v105
    v_exp_f32 v106, v106
    v_smfmac_f32_32x32x32_bf16 v[16:31], v[172:175], v[120:127], v44
    v_exp_f32 v107, v107
    v_exp_f32 v108, v108
    v_exp_f32 v109, v109
    v_smfmac_f32_16x16x64_bf16 v[36:39], v[40:43], v[120:127], v44
    v_exp_f32 v110, v110
    v_exp_f32 v111, v111
    s_waitcnt lgkmcnt(0)
    v_exp_f32 v144, v144
    v_exp_f32 v145, v145
    v_exp_f32 v146, v146
    v_exp_f32 v147, v147
    v_exp_f32 v148, v148
    v_exp_f32 v149, v149
    v_smfmac_f32_32x32x32_bf16 v[0:15], v[184:187], v[96:103], v44
    v_exp_f32 v150, v150
    v_exp_f32 v151, v151
    v_smfmac_f32_16x16x64_bf16 v[32:35], v[40:43], v[96:103], v44
    v_exp_f32 v152, v152
    v_exp_f32 v153, v153
    v_exp_f32 v154, v154
    v_smfmac_f32_32x32x32_bf16 v[0:15], v[188:191], v[104:111], v44
    v_exp_f32 v155, v155
    v_exp_f32 v156, v156
    v_exp_f32 v157, v157
    v_smfmac_f32_16x16x64_bf16 v[32:35], v[40:43], v[104:111], v44
    v_exp_f32 v158, v158
    v_exp_f32 v159, v159
    s_nop 1
    v_smfmac_f32_32x32x32_bf16 v[16:31], v[184:187], v[144:151], v44
    v_smfmac_f32_16x16x64_bf16 v[36:39], v[40:43], v[144:151], v44
    v_smfmac_f32_32x32x32_bf16 v[16:31], v[188:191], v[152:159], v44
    v_smfmac_f32_16x16x64_bf16 v[36:39], v[40:43], v[152:159], v44
    v_add_u32 v192, s53, v254
    s_xor_b32 s60, s53, 16384
    v_add_u32 v193, s60, v254
    s_add_u32 s61, s50, 1
    s_and_b32 s61, s61, 3
    s_lshl_b32 s61, s61, 13
    s_add_u32 s61, s61, s34
    buffer_load_dwordx4 v[160:163], v254, s[12:15], s61 offen offset:0 sc1
    buffer_load_dwordx4 v[164:167], v254, s[12:15], s61 offen offset:1024 sc1
    buffer_load_dwordx4 v[168:171], v254, s[12:15], s61 offen offset:2048 sc1
    buffer_load_dwordx4 v[172:175], v254, s[12:15], s61 offen offset:3072 sc1
    s_nop 7
    s_nop 3
    ds_write_b128 v192, v[16:19] offset:0
    ds_write_b128 v192, v[20:23] offset:1024
    ds_write_b128 v192, v[24:27] offset:2048
    ds_write_b128 v192, v[28:31] offset:3072
    ds_write_b128 v192, v[36:39] offset:32768
    s_add_u32 s61, s61, 4096
    buffer_load_dwordx4 v[176:179], v254, s[12:15], s61 offen offset:0 sc1
    buffer_load_dwordx4 v[180:183], v254, s[12:15], s61 offen offset:1024 sc1
    buffer_load_dwordx4 v[184:187], v254, s[12:15], s61 offen offset:2048 sc1
    buffer_load_dwordx4 v[188:191], v254, s[12:15], s61 offen offset:3072 sc1
    s_waitcnt lgkmcnt(0)
    s_barrier
    ds_read_b128 v[80:83], v193 offset:0
    ds_read_b128 v[84:87], v193 offset:1024
    ds_read_b128 v[88:91], v193 offset:2048
    ds_read_b128 v[92:95], v193 offset:3072
    ds_read_b128 v[64:67], v193 offset:32768
    s_waitcnt lgkmcnt(0)
    v_add_f32 v0, v0, v80
    v_add_f32 v1, v1, v81
    v_add_f32 v2, v2, v82
    v_add_f32 v3, v3, v83
    v_add_f32 v4, v4, v84
    v_add_f32 v5, v5, v85
    v_add_f32 v6, v6, v86
    v_add_f32 v7, v7, v87
    v_add_f32 v8, v8, v88
    v_add_f32 v9, v9, v89
    v_add_f32 v10, v10, v90
    v_add_f32 v11, v11, v91
    v_add_f32 v12, v12, v92
    v_add_f32 v13, v13, v93
    v_add_f32 v14, v14, v94
    v_add_f32 v15, v15, v95
    v_add_f32 v32, v32, v64
    v_add_f32 v196, v0, v1
    v_add_f32 v197, v2, v3
    v_add_f32 v198, v4, v5
    v_add_f32 v199, v6, v7
    v_add_f32 v200, v8, v9
    v_add_f32 v201, v10, v11
    v_add_f32 v202, v12, v13
    v_add_f32 v203, v14, v15
    v_add_f32 v196, v196, v200
    v_add_f32 v197, v197, v201
    v_add_f32 v198, v198, v202
    v_add_f32 v199, v199, v203
    v_add_f32 v196, v196, v198
    v_add_f32 v197, v197, v199
    v_add_f32 v196, v196, v197
    v_fma_f32 v194, v196, 0, v32
    s_mov_b32 s60, 0x53800000
    v_cmp_nlt_f32 vcc, v194, s60
    s_nop 4
    s_cbranch_vccz L_at_fin
    v_mov_b32 v0, 0
    v_mov_b32 v1, 0
    v_mov_b32 v2, 0
    v_mov_b32 v3, 0
    v_mov_b32 v4, 0
    v_mov_b32 v5, 0
    v_mov_b32 v6, 0
    v_mov_b32 v7, 0
    v_mov_b32 v8, 0
    v_mov_b32 v9, 0
    v_mov_b32 v10, 0
    v_mov_b32 v11, 0
    v_mov_b32 v12, 0
    v_mov_b32 v13, 0
    v_mov_b32 v14, 0
    v_mov_b32 v15, 0
    v_mov_b32 v196, 0xff800000
    v_mov_b32 v197, 0
    s_mov_b32 s60, s29
    s_mov_b32 s61, 64
L_fb:
    buffer_load_dwordx4 v[48:51], v254, s[12:15], s60 offen offset:0 sc1
    buffer_load_dwordx4 v[52:55], v254, s[12:15], s60 offen offset:1024 sc1
    buffer_load_dwordx4 v[56:59], v254, s[12:15], s60 offen offset:2048 sc1
    buffer_load_dwordx4 v[60:63], v254, s[12:15], s60 offen offset:3072 sc1
    s_waitcnt vmcnt(0)
    v_mfma_f32_32x32x16_bf16 v[80:95], v[48:51], v[128:131], 0
    v_mfma_f32_32x32x16_bf16 v[80:95], v[52:55], v[132:135], v[80:95]
    s_nop 7
    s_nop 3
    v_max3_f32 v199, v80, v81, v82
    v_max3_f32 v199, v199, v83, v84
    v_max3_f32 v199, v199, v85, v86
    v_max3_f32 v199, v199, v87, v88
    v_max3_f32 v199, v199, v89, v90
    v_max3_f32 v199, v199, v91, v92
    v_max3_f32 v199, v199, v93, v94
    v_max_f32 v199, v199, v95
    v_mov_b32 v200, v199
    s_nop 1
    v_permlane32_swap_b32 v199, v200
    s_nop 1
    v_max_f32 v199, v199, v200
    v_max_f32 v199, v199, v196
    v_sub_f32 v198, v196, v199
    v_exp_f32 v198, v198
    v_mov_b32 v196, v199
    v_sub_f32 v80, v80, v196
    v_sub_f32 v81, v81, v196
    v_sub_f32 v82, v82, v196
    v_sub_f32 v83, v83, v196
    v_sub_f32 v84, v84, v196
    v_sub_f32 v85, v85, v196
    v_sub_f32 v86, v86, v196
    v_sub_f32 v87, v87, v196
    v_sub_f32 v88, v88, v196
    v_sub_f32 v89, v89, v196
    v_sub_f32 v90, v90, v196
    v_sub_f32 v91, v91, v196
    v_sub_f32 v92, v92, v196
    v_sub_f32 v93, v93, v196
    v_sub_f32 v94, v94, v196
    v_sub_f32 v95, v95, v196
    v_exp_f32 v80, v80
    v_exp_f32 v81, v81
    v_exp_f32 v82, v82
    v_exp_f32 v83, v83
    v_exp_f32 v84, v84
    v_exp_f32 v85, v85
    v_exp_f32 v86, v86
    v_exp_f32 v87, v87
    v_exp_f32 v88, v88
    v_exp_f32 v89, v89
    v_exp_f32 v90, v90
    v_exp_f32 v91, v91
    v_exp_f32 v92, v92
    v_exp_f32 v93, v93
    v_exp_f32 v94, v94
    v_exp_f32 v95, v95
    v_mul_f32 v197, v197, v198
    v_and_b32 v200, 0xffff0000, v80
    v_add_f32 v197, v197, v200
    v_and_b32 v200, 0xffff0000, v81
    v_add_f32 v197, v197, v200
    v_and_b32 v200, 0xffff0000, v82
    v_add_f32 v197, v197, v200
    v_and_b32 v200, 0xffff0000, v83
    v_add_f32 v197, v197, v200
    v_and_b32 v200, 0xffff0000, v84
    v_add_f32 v197, v197, v200
    v_and_b32 v200, 0xffff0000, v85
    v_add_f32 v197, v197, v200
    v_and_b32 v200, 0xffff0000, v86
    v_add_f32 v197, v197, v200
    v_and_b32 v200, 0xffff0000, v87
    v_add_f32 v197, v197, v200
    v_and_b32 v200, 0xffff0000, v88
    v_add_f32 v197, v197, v200
    v_and_b32 v200, 0xffff0000, v89
    v_add_f32 v197, v197, v200
    v_and_b32 v200, 0xffff0000, v90
    v_add_f32 v197, v197, v200
    v_and_b32 v200, 0xffff0000, v91
    v_add_f32 v197, v197, v200
    v_and_b32 v200, 0xffff0000, v92
    v_add_f32 v197, v197, v200
    v_and_b32 v200, 0xffff0000, v93
    v_add_f32 v197, v197, v200
    v_and_b32 v200, 0xffff0000, v94
    v_add_f32 v197, v197, v200
    v_and_b32 v200, 0xffff0000, v95
    v_add_f32 v197, v197, v200
    v_mul_f32 v0, v0, v198
    v_mul_f32 v1, v1, v198
    v_mul_f32 v2, v2, v198
    v_mul_f32 v3, v3, v198
    v_mul_f32 v4, v4, v198
    v_mul_f32 v5, v5, v198
    v_mul_f32 v6, v6, v198
    v_mul_f32 v7, v7, v198
    v_mul_f32 v8, v8, v198
    v_mul_f32 v9, v9, v198
    v_mul_f32 v10, v10, v198
    v_mul_f32 v11, v11, v198
    v_mul_f32 v12, v12, v198
    v_mul_f32 v13, v13, v198
    v_mul_f32 v14, v14, v198
    v_mul_f32 v15, v15, v198
    s_nop 1
    v_smfmac_f32_32x32x32_bf16 v[0:15], v[56:59], v[80:87], v44
    v_smfmac_f32_32x32x32_bf16 v[0:15], v[60:63], v[88:95], v44
    s_add_u32 s60, s60, 4096
    s_sub_u32 s61, s61, 1
    s_cmp_lg_u32 s61, 0
    s_nop 7
    s_nop 7
    s_cbranch_scc1 L_fb
    v_mov_b32 v200, v197
    s_nop 1
    v_permlane32_swap_b32 v197, v200
    s_nop 1
    v_add_f32 v197, v197, v200
    v_mov_b32 v32, v197
L_at_fin:
    v_rcp_f32 v195, v32
    s_nop 0
    v_mul_f32 v0, v195, v0
    v_mul_f32 v1, v195, v1
    v_mul_f32 v2, v195, v2
    v_mul_f32 v3, v195, v3
    v_mul_f32 v4, v195, v4
    v_mul_f32 v5, v195, v5
    v_mul_f32 v6, v195, v6
    v_mul_f32 v7, v195, v7
    v_mul_f32 v8, v195, v8
    v_mul_f32 v9, v195, v9
    v_mul_f32 v10, v195, v10
    v_mul_f32 v11, v195, v11
    v_mul_f32 v12, v195, v12
    v_mul_f32 v13, v195, v13
    v_mul_f32 v14, v195, v14
    v_mul_f32 v15, v195, v15
    v_cvt_pk_bf16_f32 v48, v0, v1
    v_cvt_pk_bf16_f32 v49, v2, v3
    v_cvt_pk_bf16_f32 v50, v4, v5
    v_cvt_pk_bf16_f32 v51, v6, v7
    v_cvt_pk_bf16_f32 v52, v8, v9
    v_cvt_pk_bf16_f32 v53, v10, v11
    v_cvt_pk_bf16_f32 v54, v12, v13
    v_cvt_pk_bf16_f32 v55, v14, v15
    buffer_store_dwordx4 v[48:51], v254, s[12:15], s56 offen offset:0 sc1
    buffer_store_dwordx4 v[52:55], v254, s[12:15], s56 offen offset:1024 sc1
    buffer_load_dwordx4 v[124:127], v254, s[12:15], s69 offen offset:3072 sc1
    s_waitcnt vmcnt(1)
    s_barrier
    s_cmp_lg_u32 s22, 0
    s_cbranch_scc1 L_fs_f3
    v_mov_b32 v207, s26
    v_lshlrev_b32 v206, 2, v255
    buffer_store_dword v207, v206, s[12:15], s45 offen sc1
L_fs_f3:
    s_add_u32 s61, s50, 3
    s_and_b32 s61, s61, 3
    s_lshl_b32 s61, s61, 18
    s_add_u32 s61, s61, s38
    s_add_u32 m0, s39, 32768
    s_nop 0
    buffer_load_dwordx4 v224, s[4:7], s61 offen lds
    s_add_u32 m0, s39, 33792
    s_nop 0
    buffer_load_dwordx4 v225, s[4:7], s61 offen lds
    s_add_u32 m0, s39, 40960
    s_nop 0
    buffer_load_dwordx4 v226, s[4:7], s61 offen lds
    s_add_u32 m0, s39, 41984
    s_nop 0
    buffer_load_dwordx4 v227, s[4:7], s61 offen lds
    v_add_u32 v222, 98304, v228
    v_xor_b32 v223, 8192, v228
    v_add_u32 v223, 98304, v223
    ds_read_b64_tr_b16 v[192:193], v222 offset:0
    ds_read_b64_tr_b16 v[194:195], v222 offset:512
    ds_read_b64_tr_b16 v[196:197], v223 offset:0
    ds_read_b64_tr_b16 v[198:199], v223 offset:512
    s_waitcnt lgkmcnt(2)
    ds_read_b64_tr_b16 v[200:201], v222 offset:1024
    ds_read_b64_tr_b16 v[202:203], v222 offset:1536
    v_mfma_f32_32x32x16_bf16 v[0:15], v[192:195], v[236:239], 0
    s_waitcnt lgkmcnt(2)
    ds_read_b64_tr_b16 v[204:205], v223 offset:1024
    ds_read_b64_tr_b16 v[206:207], v223 offset:1536
    v_mfma_f32_32x32x16_bf16 v[16:31], v[196:199], v[236:239], 0
    s_add_u32 s61, s50, 2
    s_and_b32 s61, s61, 3
    s_lshl_b32 s61, s61, 13
    s_add_u32 s61, s61, s34
    buffer_load_dwordx4 v[128:131], v254, s[12:15], s61 offen offset:0 sc1
    buffer_load_dwordx4 v[132:135], v254, s[12:15], s61 offen offset:1024 sc1
    s_waitcnt lgkmcnt(2)
    ds_read_b64_tr_b16 v[192:193], v222 offset:2048
    ds_read_b64_tr_b16 v[194:195], v222 offset:2560
    v_mfma_f32_32x32x16_bf16 v[0:15], v[200:203], v[240:243], v[0:15]
    s_waitcnt lgkmcnt(2)
    ds_read_b64_tr_b16 v[196:197], v223 offset:2048
    ds_read_b64_tr_b16 v[198:199], v223 offset:2560
    v_mfma_f32_32x32x16_bf16 v[16:31], v[204:207], v[240:243], v[16:31]
    buffer_load_dwordx4 v[136:139], v254, s[12:15], s61 offen offset:2048 sc1
    buffer_load_dwordx4 v[140:143], v254, s[12:15], s61 offen offset:3072 sc1
    s_waitcnt lgkmcnt(2)
    ds_read_b64_tr_b16 v[200:201], v222 offset:3072
    ds_read_b64_tr_b16 v[202:203], v222 offset:3584
    v_mfma_f32_32x32x16_bf16 v[0:15], v[192:195], v[244:247], v[0:15]
    s_waitcnt lgkmcnt(2)
    ds_read_b64_tr_b16 v[204:205], v223 offset:3072
    ds_read_b64_tr_b16 v[206:207], v223 offset:3584
    v_mfma_f32_32x32x16_bf16 v[16:31], v[196:199], v[244:247], v[16:31]
    s_add_u32 s61, s61, 4096
    buffer_load_dwordx4 v[144:147], v254, s[12:15], s61 offen offset:0 sc1
    buffer_load_dwordx4 v[148:151], v254, s[12:15], s61 offen offset:1024 sc1
    s_waitcnt lgkmcnt(2)
    ds_read_b64_tr_b16 v[192:193], v222 offset:4096
    ds_read_b64_tr_b16 v[194:195], v222 offset:4608
    v_mfma_f32_32x32x16_bf16 v[0:15], v[200:203], v[248:251], v[0:15]
    s_waitcnt lgkmcnt(2)
    ds_read_b64_tr_b16 v[196:197], v223 offset:4096
    ds_read_b64_tr_b16 v[198:199], v223 offset:4608
    v_mfma_f32_32x32x16_bf16 v[16:31], v[204:207], v[248:251], v[16:31]
    buffer_load_dwordx4 v[152:155], v254, s[12:15], s61 offen offset:2048 sc1
    buffer_load_dwordx4 v[156:159], v254, s[12:15], s61 offen offset:3072 sc1
    s_waitcnt lgkmcnt(2)
    ds_read_b64_tr_b16 v[200:201], v222 offset:5120
    ds_read_b64_tr_b16 v[202:203], v222 offset:5632
    v_mfma_f32_32x32x16_bf16 v[0:15], v[192:195], v[208:211], v[0:15]
    s_waitcnt lgkmcnt(2)
    ds_read_b64_tr_b16 v[204:205], v223 offset:5120
    ds_read_b64_tr_b16 v[206:207], v223 offset:5632
    v_mfma_f32_32x32x16_bf16 v[16:31], v[196:199], v[208:211], v[16:31]
    s_add_u32 s61, s50, 0
    s_and_b32 s61, s61, 3
    s_lshl_b32 s61, s61, 18
    s_add_u32 s61, s61, s38
    s_add_u32 m0, s39, 0
    s_nop 0
    buffer_load_dwordx4 v224, s[8:11], s61 offen lds
    s_add_u32 m0, s39, 1024
    s_nop 0
    buffer_load_dwordx4 v225, s[8:11], s61 offen lds
    s_waitcnt lgkmcnt(2)
    ds_read_b64_tr_b16 v[192:193], v222 offset:6144
    ds_read_b64_tr_b16 v[194:195], v222 offset:6656
    v_mfma_f32_32x32x16_bf16 v[0:15], v[200:203], v[212:215], v[0:15]
    s_waitcnt lgkmcnt(2)
    ds_read_b64_tr_b16 v[196:197], v223 offset:6144
    ds_read_b64_tr_b16 v[198:199], v223 offset:6656
    v_mfma_f32_32x32x16_bf16 v[16:31], v[204:207], v[212:215], v[16:31]
    s_add_u32 m0, s39, 8192
    s_nop 0
    buffer_load_dwordx4 v226, s[8:11], s61 offen lds
    s_waitcnt lgkmcnt(2)
    ds_read_b64_tr_b16 v[200:201], v222 offset:7168
    ds_read_b64_tr_b16 v[202:203], v222 offset:7680
    v_mfma_f32_32x32x16_bf16 v[0:15], v[192:195], v[216:219], v[0:15]
    s_waitcnt lgkmcnt(2)
    ds_read_b64_tr_b16 v[204:205], v223 offset:7168
    ds_read_b64_tr_b16 v[206:207], v223 offset:7680
    v_mfma_f32_32x32x16_bf16 v[16:31], v[196:199], v[216:219], v[16:31]
    s_add_u32 m0, s39, 9216
    s_nop 0
    buffer_load_dwordx4 v227, s[8:11], s61 offen lds
    s_waitcnt vmcnt(16) lgkmcnt(0)
    s_barrier
    v_add_u32 v222, 0x8000, v222
    v_add_u32 v223, 0x8000, v223
    ds_read_b64_tr_b16 v[192:193], v222 offset:0
    ds_read_b64_tr_b16 v[194:195], v222 offset:512
    v_mfma_f32_32x32x16_bf16 v[0:15], v[200:203], v[124:127], v[0:15]
    ds_read_b64_tr_b16 v[196:197], v223 offset:0
    ds_read_b64_tr_b16 v[198:199], v223 offset:512
    v_mfma_f32_32x32x16_bf16 v[16:31], v[204:207], v[124:127], v[16:31]
    s_waitcnt lgkmcnt(2)
    ds_read_b64_tr_b16 v[200:201], v222 offset:1024
    ds_read_b64_tr_b16 v[202:203], v222 offset:1536
    v_mfma_f32_32x32x16_bf16 v[0:15], v[192:195], v[160:163], v[0:15]
    s_waitcnt lgkmcnt(2)
    ds_read_b64_tr_b16 v[204:205], v223 offset:1024
    ds_read_b64_tr_b16 v[206:207], v223 offset:1536
    v_mfma_f32_32x32x16_bf16 v[16:31], v[196:199], v[160:163], v[16:31]
    s_add_u32 s61, s50, 3
    s_and_b32 s61, s61, 3
    s_lshl_b32 s61, s61, 13
    s_add_u32 s61, s61, s34
    buffer_load_dwordx4 v[64:67], v254, s[12:15], s61 offen offset:0 sc1
    buffer_load_dwordx4 v[68:71], v254, s[12:15], s61 offen offset:1024 sc1
    s_waitcnt lgkmcnt(2)
    ds_read_b64_tr_b16 v[192:193], v222 offset:2048
    ds_read_b64_tr_b16 v[194:195], v222 offset:2560
    v_mfma_f32_32x32x16_bf16 v[0:15], v[200:203], v[164:167], v[0:15]
    s_waitcnt lgkmcnt(2)
    ds_read_b64_tr_b16 v[196:197], v223 offset:2048
    ds_read_b64_tr_b16 v[198:199], v223 offset:2560
    v_mfma_f32_32x32x16_bf16 v[16:31], v[204:207], v[164:167], v[16:31]
    buffer_load_dwordx4 v[72:75], v254, s[12:15], s61 offen offset:2048 sc1
    buffer_load_dwordx4 v[76:79], v254, s[12:15], s61 offen offset:3072 sc1
    s_waitcnt lgkmcnt(2)
    ds_read_b64_tr_b16 v[200:201], v222 offset:3072
    ds_read_b64_tr_b16 v[202:203], v222 offset:3584
    v_mfma_f32_32x32x16_bf16 v[0:15], v[192:195], v[168:171], v[0:15]
    s_waitcnt lgkmcnt(2)
    ds_read_b64_tr_b16 v[204:205], v223 offset:3072
    ds_read_b64_tr_b16 v[206:207], v223 offset:3584
    v_mfma_f32_32x32x16_bf16 v[16:31], v[196:199], v[168:171], v[16:31]
    s_add_u32 s61, s61, 4096
    buffer_load_dwordx4 v[80:83], v254, s[12:15], s61 offen offset:0 sc1
    s_waitcnt lgkmcnt(2)
    ds_read_b64_tr_b16 v[192:193], v222 offset:4096
    ds_read_b64_tr_b16 v[194:195], v222 offset:4608
    v_mfma_f32_32x32x16_bf16 v[0:15], v[200:203], v[172:175], v[0:15]
    s_waitcnt lgkmcnt(2)
    ds_read_b64_tr_b16 v[196:197], v223 offset:4096
    ds_read_b64_tr_b16 v[198:199], v223 offset:4608
    v_mfma_f32_32x32x16_bf16 v[16:31], v[204:207], v[172:175], v[16:31]
    buffer_load_dwordx4 v[84:87], v254, s[12:15], s61 offen offset:1024 sc1
    s_waitcnt lgkmcnt(2)
    ds_read_b64_tr_b16 v[200:201], v222 offset:5120
    ds_read_b64_tr_b16 v[202:203], v222 offset:5632
    v_mfma_f32_32x32x16_bf16 v[0:15], v[192:195], v[176:179], v[0:15]
    s_waitcnt lgkmcnt(2)
    ds_read_b64_tr_b16 v[204:205], v223 offset:5120
    ds_read_b64_tr_b16 v[206:207], v223 offset:5632
    v_mfma_f32_32x32x16_bf16 v[16:31], v[196:199], v[176:179], v[16:31]
    buffer_load_dwordx4 v[88:91], v254, s[12:15], s61 offen offset:2048 sc1
    s_waitcnt lgkmcnt(2)
    ds_read_b64_tr_b16 v[192:193], v222 offset:6144
    ds_read_b64_tr_b16 v[194:195], v222 offset:6656
    v_mfma_f32_32x32x16_bf16 v[0:15], v[200:203], v[180:183], v[0:15]
    s_waitcnt lgkmcnt(2)
    ds_read_b64_tr_b16 v[196:197], v223 offset:6144
    ds_read_b64_tr_b16 v[198:199], v223 offset:6656
    v_mfma_f32_32x32x16_bf16 v[16:31], v[204:207], v[180:183], v[16:31]
    buffer_load_dwordx4 v[92:95], v254, s[12:15], s61 offen offset:3072 sc1
    s_waitcnt lgkmcnt(2)
    ds_read_b64_tr_b16 v[200:201], v222 offset:7168
    ds_read_b64_tr_b16 v[202:203], v222 offset:7680
    v_mfma_f32_32x32x16_bf16 v[0:15], v[192:195], v[184:187], v[0:15]
    s_waitcnt lgkmcnt(2)
    ds_read_b64_tr_b16 v[204:205], v223 offset:7168
    ds_read_b64_tr_b16 v[206:207], v223 offset:7680
    v_mfma_f32_32x32x16_bf16 v[16:31], v[196:199], v[184:187], v[16:31]
    buffer_load_dword v221, v234, s[12:15], s41 offen sc1
    s_waitcnt vmcnt(13) lgkmcnt(0)
    s_barrier
    v_add_u32 v222, 0xffff0000, v222
    v_add_u32 v223, 0xffff0000, v223
    ds_read_b64_tr_b16 v[192:193], v222 offset:0
    ds_read_b64_tr_b16 v[194:195], v222 offset:512
    v_mfma_f32_32x32x16_bf16 v[0:15], v[200:203], v[188:191], v[0:15]
    ds_read_b64_tr_b16 v[196:197], v223 offset:0
    ds_read_b64_tr_b16 v[198:199], v223 offset:512
    v_mfma_f32_32x32x16_bf16 v[16:31], v[204:207], v[188:191], v[16:31]
    s_add_u32 s61, s50, 1
    s_and_b32 s61, s61, 3
    s_lshl_b32 s61, s61, 18
    s_add_u32 s61, s61, s38
    s_add_u32 m0, s39, 98304
    s_nop 0
    buffer_load_dwordx4 v224, s[8:11], s61 offen lds
    s_add_u32 m0, s39, 99328
    s_nop 0
    buffer_load_dwordx4 v225, s[8:11], s61 offen lds
    s_add_u32 m0, s39, 106496
    s_nop 0
    buffer_load_dwordx4 v226, s[8:11], s61 offen lds
    s_add_u32 m0, s39, 107520
    s_nop 0
    buffer_load_dwordx4 v227, s[8:11], s61 offen lds
    s_mov_b32 s60, 32768
    s_waitcnt vmcnt(4)
    s_branch L_poll_f3_chk
L_poll_f3:
    s_waitcnt vmcnt(0)
L_poll_f3_chk:
    v_cmp_ne_u32 vcc, s26, v221
    s_nop 4
    s_cbranch_vccz L_poll_f3_ok
    s_sub_u32 s60, s60, 1
    s_cmp_eq_u32 s60, 0
    s_cbranch_scc1 L_poll_f3_ok
    s_sleep 2
    buffer_load_dword v221, v234, s[12:15], s41 offen sc1
    s_branch L_poll_f3
L_poll_f3_ok:
    s_waitcnt lgkmcnt(2)
    ds_read_b64_tr_b16 v[200:201], v222 offset:1024
    ds_read_b64_tr_b16 v[202:203], v222 offset:1536
    v_mfma_f32_32x32x16_bf16 v[0:15], v[192:195], v[128:131], v[0:15]
    s_waitcnt lgkmcnt(2)
    ds_read_b64_tr_b16 v[204:205], v223 offset:1024
    ds_read_b64_tr_b16 v[206:207], v223 offset:1536
    v_mfma_f32_32x32x16_bf16 v[16:31], v[196:199], v[128:131], v[16:31]
    s_add_u32 s61, s50, 0
    s_and_b32 s61, s61, 3
    s_lshl_b32 s61, s61, 13
    s_add_u32 s61, s61, s35
    buffer_load_dwordx4 v[96:99], v254, s[12:15], s61 offen offset:0 sc1
    buffer_load_dwordx4 v[100:103], v254, s[12:15], s61 offen offset:1024 sc1
    s_waitcnt lgkmcnt(2)
    ds_read_b64_tr_b16 v[192:193], v222 offset:2048
    ds_read_b64_tr_b16 v[194:195], v222 offset:2560
    v_mfma_f32_32x32x16_bf16 v[0:15], v[200:203], v[132:135], v[0:15]
    s_waitcnt lgkmcnt(2)
    ds_read_b64_tr_b16 v[196:197], v223 offset:2048
    ds_read_b64_tr_b16 v[198:199], v223 offset:2560
    v_mfma_f32_32x32x16_bf16 v[16:31], v[204:207], v[132:135], v[16:31]
    buffer_load_dwordx4 v[104:107], v254, s[12:15], s61 offen offset:2048 sc1
    s_waitcnt lgkmcnt(2)
    ds_read_b64_tr_b16 v[200:201], v222 offset:3072
    ds_read_b64_tr_b16 v[202:203], v222 offset:3584
    v_mfma_f32_32x32x16_bf16 v[0:15], v[192:195], v[136:139], v[0:15]
    s_waitcnt lgkmcnt(2)
    ds_read_b64_tr_b16 v[204:205], v223 offset:3072
    ds_read_b64_tr_b16 v[206:207], v223 offset:3584
    v_mfma_f32_32x32x16_bf16 v[16:31], v[196:199], v[136:139], v[16:31]
    buffer_load_dwordx4 v[108:111], v254, s[12:15], s61 offen offset:3072 sc1
    s_waitcnt lgkmcnt(2)
    ds_read_b64_tr_b16 v[192:193], v222 offset:4096
    ds_read_b64_tr_b16 v[194:195], v222 offset:4608
    v_mfma_f32_32x32x16_bf16 v[0:15], v[200:203], v[140:143], v[0:15]
    s_waitcnt lgkmcnt(2)
    ds_read_b64_tr_b16 v[196:197], v223 offset:4096
    ds_read_b64_tr_b16 v[198:199], v223 offset:4608
    v_mfma_f32_32x32x16_bf16 v[16:31], v[204:207], v[140:143], v[16:31]
    s_add_u32 s61, s61, 4096
    buffer_load_dwordx4 v[112:115], v254, s[12:15], s61 offen offset:0 sc1
    s_waitcnt lgkmcnt(2)
    ds_read_b64_tr_b16 v[200:201], v222 offset:5120
    ds_read_b64_tr_b16 v[202:203], v222 offset:5632
    v_mfma_f32_32x32x16_bf16 v[0:15], v[192:195], v[144:147], v[0:15]
    s_waitcnt lgkmcnt(2)
    ds_read_b64_tr_b16 v[204:205], v223 offset:5120
    ds_read_b64_tr_b16 v[206:207], v223 offset:5632
    v_mfma_f32_32x32x16_bf16 v[16:31], v[196:199], v[144:147], v[16:31]
    buffer_load_dwordx4 v[116:119], v254, s[12:15], s61 offen offset:1024 sc1
    s_waitcnt lgkmcnt(2)
    ds_read_b64_tr_b16 v[192:193], v222 offset:6144
    ds_read_b64_tr_b16 v[194:195], v222 offset:6656
    v_mfma_f32_32x32x16_bf16 v[0:15], v[200:203], v[148:151], v[0:15]
    s_waitcnt lgkmcnt(2)
    ds_read_b64_tr_b16 v[196:197], v223 offset:6144
    ds_read_b64_tr_b16 v[198:199], v223 offset:6656
    v_mfma_f32_32x32x16_bf16 v[16:31], v[204:207], v[148:151], v[16:31]
    buffer_load_dwordx4 v[120:123], v254, s[12:15], s61 offen offset:2048 sc1
    s_waitcnt lgkmcnt(2)
    ds_read_b64_tr_b16 v[200:201], v222 offset:7168
    ds_read_b64_tr_b16 v[202:203], v222 offset:7680
    v_mfma_f32_32x32x16_bf16 v[0:15], v[192:195], v[152:155], v[0:15]
    s_waitcnt lgkmcnt(2)
    ds_read_b64_tr_b16 v[204:205], v223 offset:7168
    ds_read_b64_tr_b16 v[206:207], v223 offset:7680
    v_mfma_f32_32x32x16_bf16 v[16:31], v[196:199], v[152:155], v[16:31]
    buffer_load_dwordx4 v[124:127], v254, s[12:15], s61 offen offset:3072 sc1
    s_waitcnt lgkmcnt(0)
    s_barrier
    v_add_u32 v222, 0xffff8000, v222
    v_add_u32 v223, 0xffff8000, v223
    ds_read_b64_tr_b16 v[192:193], v222 offset:0
    ds_read_b64_tr_b16 v[194:195], v222 offset:512
    v_mfma_f32_32x32x16_bf16 v[0:15], v[200:203], v[156:159], v[0:15]
    ds_read_b64_tr_b16 v[196:197], v223 offset:0
    ds_read_b64_tr_b16 v[198:199], v223 offset:512
    v_mfma_f32_32x32x16_bf16 v[16:31], v[204:207], v[156:159], v[16:31]
    s_waitcnt lgkmcnt(2)
    ds_read_b64_tr_b16 v[200:201], v222 offset:1024
    ds_read_b64_tr_b16 v[202:203], v222 offset:1536
    v_mfma_f32_32x32x16_bf16 v[0:15], v[192:195], v[64:67], v[0:15]
    s_waitcnt lgkmcnt(2)
    ds_read_b64_tr_b16 v[204:205], v223 offset:1024
    ds_read_b64_tr_b16 v[206:207], v223 offset:1536
    v_mfma_f32_32x32x16_bf16 v[16:31], v[196:199], v[64:67], v[16:31]
    s_add_u32 s61, s50, 1
    s_and_b32 s61, s61, 3
    s_lshl_b32 s61, s61, 13
    s_add_u32 s61, s61, s35
    buffer_load_dwordx4 v[160:163], v254, s[12:15], s61 offen offset:0 sc1
    buffer_load_dwordx4 v[164:167], v254, s[12:15], s61 offen offset:1024 sc1
    s_waitcnt lgkmcnt(2)
    ds_read_b64_tr_b16 v[192:193], v222 offset:2048
    ds_read_b64_tr_b16 v[194:195], v222 offset:2560
    v_mfma_f32_32x32x16_bf16 v[0:15], v[200:203], v[68:71], v[0:15]
    s_waitcnt lgkmcnt(2)
    ds_read_b64_tr_b16 v[196:197], v223 offset:2048
    ds_read_b64_tr_b16 v[198:199], v223 offset:2560
    v_mfma_f32_32x32x16_bf16 v[16:31], v[204:207], v[68:71], v[16:31]
    buffer_load_dwordx4 v[168:171], v254, s[12:15], s61 offen offset:2048 sc1
    buffer_load_dwordx4 v[172:175], v254, s[12:15], s61 offen offset:3072 sc1
    s_waitcnt lgkmcnt(2)
    ds_read_b64_tr_b16 v[200:201], v222 offset:3072
    ds_read_b64_tr_b16 v[202:203], v222 offset:3584
    v_mfma_f32_32x32x16_bf16 v[0:15], v[192:195], v[72:75], v[0:15]
    s_waitcnt lgkmcnt(2)
    ds_read_b64_tr_b16 v[204:205], v223 offset:3072
    ds_read_b64_tr_b16 v[206:207], v223 offset:3584
    v_mfma_f32_32x32x16_bf16 v[16:31], v[196:199], v[72:75], v[16:31]
    s_add_u32 s61, s61, 4096
    buffer_load_dwordx4 v[176:179], v254, s[12:15], s61 offen offset:0 sc1
    buffer_load_dwordx4 v[180:183], v254, s[12:15], s61 offen offset:1024 sc1
    s_waitcnt lgkmcnt(2)
    ds_read_b64_tr_b16 v[192:193], v222 offset:4096
    ds_read_b64_tr_b16 v[194:195], v222 offset:4608
    v_mfma_f32_32x32x16_bf16 v[0:15], v[200:203], v[76:79], v[0:15]
    s_waitcnt lgkmcnt(2)
    ds_read_b64_tr_b16 v[196:197], v223 offset:4096
    ds_read_b64_tr_b16 v[198:199], v223 offset:4608
    v_mfma_f32_32x32x16_bf16 v[16:31], v[204:207], v[76:79], v[16:31]
    buffer_load_dwordx4 v[184:187], v254, s[12:15], s61 offen offset:2048 sc1
    buffer_load_dwordx4 v[188:191], v254, s[12:15], s61 offen offset:3072 sc1
    s_waitcnt lgkmcnt(2)
    ds_read_b64_tr_b16 v[200:201], v222 offset:5120
    ds_read_b64_tr_b16 v[202:203], v222 offset:5632
    v_mfma_f32_32x32x16_bf16 v[0:15], v[192:195], v[80:83], v[0:15]
    s_waitcnt lgkmcnt(2)
    ds_read_b64_tr_b16 v[204:205], v223 offset:5120
    ds_read_b64_tr_b16 v[206:207], v223 offset:5632
    v_mfma_f32_32x32x16_bf16 v[16:31], v[196:199], v[80:83], v[16:31]
    s_add_u32 s61, s50, 2
    s_and_b32 s61, s61, 3
    s_lshl_b32 s61, s61, 18
    s_add_u32 s61, s61, s38
    s_add_u32 m0, s39, 131072
    s_nop 0
    buffer_load_dwordx4 v224, s[8:11], s61 offen lds
    s_add_u32 m0, s39, 132096
    s_nop 0
    buffer_load_dwordx4 v225, s[8:11], s61 offen lds
    s_waitcnt lgkmcnt(2)
    ds_read_b64_tr_b16 v[192:193], v222 offset:6144
    ds_read_b64_tr_b16 v[194:195], v222 offset:6656
    v_mfma_f32_32x32x16_bf16 v[0:15], v[200:203], v[84:87], v[0:15]
    s_waitcnt lgkmcnt(2)
    ds_read_b64_tr_b16 v[196:197], v223 offset:6144
    ds_read_b64_tr_b16 v[198:199], v223 offset:6656
    v_mfma_f32_32x32x16_bf16 v[16:31], v[204:207], v[84:87], v[16:31]
    s_add_u32 m0, s39, 139264
    s_nop 0
    buffer_load_dwordx4 v226, s[8:11], s61 offen lds
    s_waitcnt lgkmcnt(2)
    ds_read_b64_tr_b16 v[200:201], v222 offset:7168
    ds_read_b64_tr_b16 v[202:203], v222 offset:7680
    v_mfma_f32_32x32x16_bf16 v[0:15], v[192:195], v[88:91], v[0:15]
    s_waitcnt lgkmcnt(2)
    ds_read_b64_tr_b16 v[204:205], v223 offset:7168
    ds_read_b64_tr_b16 v[206:207], v223 offset:7680
    v_mfma_f32_32x32x16_bf16 v[16:31], v[196:199], v[88:91], v[16:31]
    s_add_u32 m0, s39, 140288
    s_nop 0
    buffer_load_dwordx4 v227, s[8:11], s61 offen lds
    s_waitcnt vmcnt(12) lgkmcnt(0)
    s_barrier
    v_add_u32 v222, 0xffff8000, v222
    v_add_u32 v223, 0xffff8000, v223
    ds_read_b64_tr_b16 v[192:193], v222 offset:0
    ds_read_b64_tr_b16 v[194:195], v222 offset:512
    v_mfma_f32_32x32x16_bf16 v[0:15], v[200:203], v[92:95], v[0:15]
    ds_read_b64_tr_b16 v[196:197], v223 offset:0
    ds_read_b64_tr_b16 v[198:199], v223 offset:512
    v_mfma_f32_32x32x16_bf16 v[16:31], v[204:207], v[92:95], v[16:31]
    s_waitcnt lgkmcnt(2)
    ds_read_b64_tr_b16 v[200:201], v222 offset:1024
    ds_read_b64_tr_b16 v[202:203], v222 offset:1536
    v_mfma_f32_32x32x16_bf16 v[32:47], v[192:195], v[96:99], 0
    s_waitcnt lgkmcnt(2)
    ds_read_b64_tr_b16 v[204:205], v223 offset:1024
    ds_read_b64_tr_b16 v[206:207], v223 offset:1536
    v_mfma_f32_32x32x16_bf16 v[48:63], v[196:199], v[96:99], 0
    s_add_u32 s61, s50, 2
    s_and_b32 s61, s61, 3
    s_lshl_b32 s61, s61, 13
    s_add_u32 s61, s61, s35
    buffer_load_dwordx4 v[128:131], v254, s[12:15], s61 offen offset:0 sc1
    buffer_load_dwordx4 v[132:135], v254, s[12:15], s61 offen offset:1024 sc1
    s_waitcnt lgkmcnt(2)
    ds_read_b64_tr_b16 v[192:193], v222 offset:2048
    ds_read_b64_tr_b16 v[194:195], v222 offset:2560
    v_mfma_f32_32x32x16_bf16 v[32:47], v[200:203], v[100:103], v[32:47]
    s_waitcnt lgkmcnt(2)
    ds_read_b64_tr_b16 v[196:197], v223 offset:2048
    ds_read_b64_tr_b16 v[198:199], v223 offset:2560
    v_mfma_f32_32x32x16_bf16 v[48:63], v[204:207], v[100:103], v[48:63]
    buffer_load_dwordx4 v[136:139], v254, s[12:15], s61 offen offset:2048 sc1
    buffer_load_dwordx4 v[140:143], v254, s[12:15], s61 offen offset:3072 sc1
    s_waitcnt lgkmcnt(2)
    ds_read_b64_tr_b16 v[200:201], v222 offset:3072
    ds_read_b64_tr_b16 v[202:203], v222 offset:3584
    v_mfma_f32_32x32x16_bf16 v[32:47], v[192:195], v[104:107], v[32:47]
    s_waitcnt lgkmcnt(2)
    ds_read_b64_tr_b16 v[204:205], v223 offset:3072
    ds_read_b64_tr_b16 v[206:207], v223 offset:3584
    v_mfma_f32_32x32x16_bf16 v[48:63], v[196:199], v[104:107], v[48:63]
    s_add_u32 s61, s61, 4096
    buffer_load_dwordx4 v[144:147], v254, s[12:15], s61 offen offset:0 sc1
    buffer_load_dwordx4 v[148:151], v254, s[12:15], s61 offen offset:1024 sc1
    v_sub_f32 v208, 1.0, v231
    s_lshl_b32 s62, s22, 12
    v_add_u32 v209, s62, v254
    s_xor_b32 s62, s62, 16384
    v_add_u32 v210, s62, v254
    v_mul_f32 v0, v208, v0
    v_mul_f32 v1, v208, v1
    v_mul_f32 v2, v208, v2
    s_waitcnt lgkmcnt(2)
    ds_read_b64_tr_b16 v[192:193], v222 offset:4096
    ds_read_b64_tr_b16 v[194:195], v222 offset:4608
    v_mfma_f32_32x32x16_bf16 v[32:47], v[200:203], v[108:111], v[32:47]
    s_waitcnt lgkmcnt(2)
    ds_read_b64_tr_b16 v[196:197], v223 offset:4096
    ds_read_b64_tr_b16 v[198:199], v223 offset:4608
    v_mfma_f32_32x32x16_bf16 v[48:63], v[204:207], v[108:111], v[48:63]
    buffer_load_dwordx4 v[152:155], v254, s[12:15], s61 offen offset:2048 sc1
    buffer_load_dwordx4 v[156:159], v254, s[12:15], s61 offen offset:3072 sc1
    v_mul_f32 v3, v208, v3
    v_mul_f32 v4, v208, v4
    v_mul_f32 v5, v208, v5
    v_mul_f32 v6, v208, v6
    v_mul_f32 v7, v208, v7
    v_mul_f32 v8, v208, v8
    v_mul_f32 v9, v208, v9
    v_mul_f32 v10, v208, v10
    s_waitcnt lgkmcnt(2)
    ds_read_b64_tr_b16 v[200:201], v222 offset:5120
    ds_read_b64_tr_b16 v[202:203], v222 offset:5632
    v_mfma_f32_32x32x16_bf16 v[32:47], v[192:195], v[112:115], v[32:47]
    s_waitcnt lgkmcnt(2)
    ds_read_b64_tr_b16 v[204:205], v223 offset:5120
    ds_read_b64_tr_b16 v[206:207], v223 offset:5632
    v_mfma_f32_32x32x16_bf16 v[48:63], v[196:199], v[112:115], v[48:63]
    s_add_u32 s61, s50, 3
    s_and_b32 s61, s61, 3
    s_lshl_b32 s61, s61, 18
    s_add_u32 s61, s61, s38
    s_add_u32 m0, s39, 65536
    s_nop 0
    buffer_load_dwordx4 v224, s[8:11], s61 offen lds
    s_add_u32 m0, s39, 66560
    s_nop 0
    buffer_load_dwordx4 v225, s[8:11], s61 offen lds
    v_mul_f32 v11, v208, v11
    v_mul_f32 v12, v208, v12
    v_mul_f32 v13, v208, v13
    v_mul_f32 v14, v208, v14
    v_mul_f32 v15, v208, v15
    v_mul_f32 v16, v208, v16
    v_mul_f32 v17, v208, v17
    s_waitcnt lgkmcnt(2)
    ds_read_b64_tr_b16 v[192:193], v222 offset:6144
    ds_read_b64_tr_b16 v[194:195], v222 offset:6656
    v_mfma_f32_32x32x16_bf16 v[32:47], v[200:203], v[116:119], v[32:47]
    s_waitcnt lgkmcnt(2)
    ds_read_b64_tr_b16 v[196:197], v223 offset:6144
    ds_read_b64_tr_b16 v[198:199], v223 offset:6656
    v_mfma_f32_32x32x16_bf16 v[48:63], v[204:207], v[116:119], v[48:63]
    s_add_u32 m0, s39, 73728
    s_nop 0
    buffer_load_dwordx4 v226, s[8:11], s61 offen lds
    v_mul_f32 v18, v208, v18
    v_mul_f32 v19, v208, v19
    v_mul_f32 v20, v208, v20
    v_mul_f32 v21, v208, v21
    v_mul_f32 v22, v208, v22
    v_mul_f32 v23, v208, v23
    v_mul_f32 v24, v208, v24
    s_waitcnt lgkmcnt(2)
    ds_read_b64_tr_b16 v[200:201], v222 offset:7168
    ds_read_b64_tr_b16 v[202:203], v222 offset:7680
    v_mfma_f32_32x32x16_bf16 v[32:47], v[192:195], v[120:123], v[32:47]
    s_waitcnt lgkmcnt(2)
    ds_read_b64_tr_b16 v[204:205], v223 offset:7168
    ds_read_b64_tr_b16 v[206:207], v223 offset:7680
    v_mfma_f32_32x32x16_bf16 v[48:63], v[196:199], v[120:123], v[48:63]
    s_add_u32 m0, s39, 74752
    s_nop 0
    buffer_load_dwordx4 v227, s[8:11], s61 offen lds
    v_mul_f32 v25, v208, v25
    v_mul_f32 v26, v208, v26
    v_mul_f32 v27, v208, v27
    v_mul_f32 v28, v208, v28
    v_mul_f32 v29, v208, v29
    v_mul_f32 v30, v208, v30
    v_mul_f32 v31, v208, v31
    s_waitcnt vmcnt(16) lgkmcnt(0)
    s_barrier
    v_add_u32 v222, 0x18000, v222
    v_add_u32 v223, 0x18000, v223
    ds_read_b64_tr_b16 v[192:193], v222 offset:0
    ds_read_b64_tr_b16 v[194:195], v222 offset:512
    v_mfma_f32_32x32x16_bf16 v[32:47], v[200:203], v[124:127], v[32:47]
    ds_read_b64_tr_b16 v[196:197], v223 offset:0
    ds_read_b64_tr_b16 v[198:199], v223 offset:512
    v_mfma_f32_32x32x16_bf16 v[48:63], v[204:207], v[124:127], v[48:63]
    s_waitcnt lgkmcnt(2)
    ds_read_b64_tr_b16 v[200:201], v222 offset:1024
    ds_read_b64_tr_b16 v[202:203], v222 offset:1536
    v_mfma_f32_32x32x16_bf16 v[32:47], v[192:195], v[160:163], v[32:47]
    s_waitcnt lgkmcnt(2)
    ds_read_b64_tr_b16 v[204:205], v223 offset:1024
    ds_read_b64_tr_b16 v[206:207], v223 offset:1536
    v_mfma_f32_32x32x16_bf16 v[48:63], v[196:199], v[160:163], v[48:63]
    s_add_u32 s61, s50, 3
    s_and_b32 s61, s61, 3
    s_lshl_b32 s61, s61, 13
    s_add_u32 s61, s61, s35
    buffer_load_dwordx4 v[64:67], v254, s[12:15], s61 offen offset:0 sc1
    buffer_load_dwordx4 v[68:71], v254, s[12:15], s61 offen offset:1024 sc1
    s_waitcnt lgkmcnt(2)
    ds_read_b64_tr_b16 v[192:193], v222 offset:2048
    ds_read_b64_tr_b16 v[194:195], v222 offset:2560
    v_mfma_f32_32x32x16_bf16 v[32:47], v[200:203], v[164:167], v[32:47]
    s_waitcnt lgkmcnt(2)
    ds_read_b64_tr_b16 v[196:197], v223 offset:2048
    ds_read_b64_tr_b16 v[198:199], v223 offset:2560
    v_mfma_f32_32x32x16_bf16 v[48:63], v[204:207], v[164:167], v[48:63]
    buffer_load_dwordx4 v[72:75], v254, s[12:15], s61 offen offset:2048 sc1
    s_waitcnt lgkmcnt(2)
    ds_read_b64_tr_b16 v[200:201], v222 offset:3072
    ds_read_b64_tr_b16 v[202:203], v222 offset:3584
    v_mfma_f32_32x32x16_bf16 v[32:47], v[192:195], v[168:171], v[32:47]
    s_waitcnt lgkmcnt(2)
    ds_read_b64_tr_b16 v[204:205], v223 offset:3072
    ds_read_b64_tr_b16 v[206:207], v223 offset:3584
    v_mfma_f32_32x32x16_bf16 v[48:63], v[196:199], v[168:171], v[48:63]
    buffer_load_dwordx4 v[76:79], v254, s[12:15], s61 offen offset:3072 sc1
    s_waitcnt lgkmcnt(2)
    ds_read_b64_tr_b16 v[192:193], v222 offset:4096
    ds_read_b64_tr_b16 v[194:195], v222 offset:4608
    v_mfma_f32_32x32x16_bf16 v[32:47], v[200:203], v[172:175], v[32:47]
    s_waitcnt lgkmcnt(2)
    ds_read_b64_tr_b16 v[196:197], v223 offset:4096
    ds_read_b64_tr_b16 v[198:199], v223 offset:4608
    v_mfma_f32_32x32x16_bf16 v[48:63], v[204:207], v[172:175], v[48:63]
    s_add_u32 s61, s61, 4096
    buffer_load_dwordx4 v[80:83], v254, s[12:15], s61 offen offset:0 sc1
    s_waitcnt lgkmcnt(2)
    ds_read_b64_tr_b16 v[200:201], v222 offset:5120
    ds_read_b64_tr_b16 v[202:203], v222 offset:5632
    v_mfma_f32_32x32x16_bf16 v[32:47], v[192:195], v[176:179], v[32:47]
    s_waitcnt lgkmcnt(2)
    ds_read_b64_tr_b16 v[204:205], v223 offset:5120
    ds_read_b64_tr_b16 v[206:207], v223 offset:5632
    v_mfma_f32_32x32x16_bf16 v[48:63], v[196:199], v[176:179], v[48:63]
    buffer_load_dwordx4 v[84:87], v254, s[12:15], s61 offen offset:1024 sc1
    s_waitcnt lgkmcnt(2)
    ds_read_b64_tr_b16 v[192:193], v222 offset:6144
    ds_read_b64_tr_b16 v[194:195], v222 offset:6656
    v_mfma_f32_32x32x16_bf16 v[32:47], v[200:203], v[180:183], v[32:47]
    s_waitcnt lgkmcnt(2)
    ds_read_b64_tr_b16 v[196:197], v223 offset:6144
    ds_read_b64_tr_b16 v[198:199], v223 offset:6656
    v_mfma_f32_32x32x16_bf16 v[48:63], v[204:207], v[180:183], v[48:63]
    buffer_load_dwordx4 v[88:91], v254, s[12:15], s61 offen offset:2048 sc1
    s_waitcnt lgkmcnt(2)
    ds_read_b64_tr_b16 v[200:201], v222 offset:7168
    ds_read_b64_tr_b16 v[202:203], v222 offset:7680
    v_mfma_f32_32x32x16_bf16 v[32:47], v[192:195], v[184:187], v[32:47]
    s_waitcnt lgkmcnt(2)
    ds_read_b64_tr_b16 v[204:205], v223 offset:7168
    ds_read_b64_tr_b16 v[206:207], v223 offset:7680
    v_mfma_f32_32x32x16_bf16 v[48:63], v[196:199], v[184:187], v[48:63]
    buffer_load_dwordx4 v[92:95], v254, s[12:15], s61 offen offset:3072 sc1
    s_waitcnt vmcnt(12) lgkmcnt(0)
    s_barrier
    v_add_u32 v222, 0x8000, v222
    v_add_u32 v223, 0x8000, v223
    ds_read_b64_tr_b16 v[192:193], v222 offset:0
    ds_read_b64_tr_b16 v[194:195], v222 offset:512
    v_mfma_f32_32x32x16_bf16 v[32:47], v[200:203], v[188:191], v[32:47]
    ds_read_b64_tr_b16 v[196:197], v223 offset:0
    ds_read_b64_tr_b16 v[198:199], v223 offset:512
    v_mfma_f32_32x32x16_bf16 v[48:63], v[204:207], v[188:191], v[48:63]
    s_waitcnt lgkmcnt(2)
    ds_read_b64_tr_b16 v[200:201], v222 offset:1024
    ds_read_b64_tr_b16 v[202:203], v222 offset:1536
    v_mfma_f32_32x32x16_bf16 v[32:47], v[192:195], v[128:131], v[32:47]
    s_waitcnt lgkmcnt(2)
    ds_read_b64_tr_b16 v[204:205], v223 offset:1024
    ds_read_b64_tr_b16 v[206:207], v223 offset:1536
    v_mfma_f32_32x32x16_bf16 v[48:63], v[196:199], v[128:131], v[48:63]
    s_waitcnt lgkmcnt(2)
    ds_read_b64_tr_b16 v[192:193], v222 offset:2048
    ds_read_b64_tr_b16 v[194:195], v222 offset:2560
    v_mfma_f32_32x32x16_bf16 v[32:47], v[200:203], v[132:135], v[32:47]
    s_waitcnt lgkmcnt(2)
    ds_read_b64_tr_b16 v[196:197], v223 offset:2048
    ds_read_b64_tr_b16 v[198:199], v223 offset:2560
    v_mfma_f32_32x32x16_bf16 v[48:63], v[204:207], v[132:135], v[48:63]
    s_waitcnt lgkmcnt(2)
    ds_read_b64_tr_b16 v[200:201], v222 offset:3072
    ds_read_b64_tr_b16 v[202:203], v222 offset:3584
    v_mfma_f32_32x32x16_bf16 v[32:47], v[192:195], v[136:139], v[32:47]
    s_waitcnt lgkmcnt(2)
    ds_read_b64_tr_b16 v[204:205], v223 offset:3072
    ds_read_b64_tr_b16 v[206:207], v223 offset:3584
    v_mfma_f32_32x32x16_bf16 v[48:63], v[196:199], v[136:139], v[48:63]
    s_waitcnt lgkmcnt(2)
    ds_read_b64_tr_b16 v[192:193], v222 offset:4096
    ds_read_b64_tr_b16 v[194:195], v222 offset:4608
    v_mfma_f32_32x32x16_bf16 v[32:47], v[200:203], v[140:143], v[32:47]
    s_waitcnt lgkmcnt(2)
    ds_read_b64_tr_b16 v[196:197], v223 offset:4096
    ds_read_b64_tr_b16 v[198:199], v223 offset:4608
    v_mfma_f32_32x32x16_bf16 v[48:63], v[204:207], v[140:143], v[48:63]
    s_waitcnt lgkmcnt(2)
    ds_read_b64_tr_b16 v[200:201], v222 offset:5120
    ds_read_b64_tr_b16 v[202:203], v222 offset:5632
    v_mfma_f32_32x32x16_bf16 v[32:47], v[192:195], v[144:147], v[32:47]
    s_waitcnt lgkmcnt(2)
    ds_read_b64_tr_b16 v[204:205], v223 offset:5120
    ds_read_b64_tr_b16 v[206:207], v223 offset:5632
    v_mfma_f32_32x32x16_bf16 v[48:63], v[196:199], v[144:147], v[48:63]
    s_waitcnt lgkmcnt(2)
    ds_read_b64_tr_b16 v[192:193], v222 offset:6144
    ds_read_b64_tr_b16 v[194:195], v222 offset:6656
    v_mfma_f32_32x32x16_bf16 v[32:47], v[200:203], v[148:151], v[32:47]
    s_waitcnt lgkmcnt(2)
    ds_read_b64_tr_b16 v[196:197], v223 offset:6144
    ds_read_b64_tr_b16 v[198:199], v223 offset:6656
    v_mfma_f32_32x32x16_bf16 v[48:63], v[204:207], v[148:151], v[48:63]
    s_waitcnt lgkmcnt(2)
    ds_read_b64_tr_b16 v[200:201], v222 offset:7168
    ds_read_b64_tr_b16 v[202:203], v222 offset:7680
    v_mfma_f32_32x32x16_bf16 v[32:47], v[192:195], v[152:155], v[32:47]
    s_waitcnt lgkmcnt(2)
    ds_read_b64_tr_b16 v[204:205], v223 offset:7168
    ds_read_b64_tr_b16 v[206:207], v223 offset:7680
    v_mfma_f32_32x32x16_bf16 v[48:63], v[196:199], v[152:155], v[48:63]
    s_waitcnt vmcnt(0) lgkmcnt(0)
    s_barrier
    v_add_u32 v222, 0xffff0000, v222
    v_add_u32 v223, 0xffff0000, v223
    ds_read_b64_tr_b16 v[192:193], v222 offset:0
    ds_read_b64_tr_b16 v[194:195], v222 offset:512
    v_mfma_f32_32x32x16_bf16 v[32:47], v[200:203], v[156:159], v[32:47]
    ds_read_b64_tr_b16 v[196:197], v223 offset:0
    ds_read_b64_tr_b16 v[198:199], v223 offset:512
    v_mfma_f32_32x32x16_bf16 v[48:63], v[204:207], v[156:159], v[48:63]
    s_waitcnt lgkmcnt(2)
    ds_read_b64_tr_b16 v[200:201], v222 offset:1024
    ds_read_b64_tr_b16 v[202:203], v222 offset:1536
    v_mfma_f32_32x32x16_bf16 v[32:47], v[192:195], v[64:67], v[32:47]
    s_waitcnt lgkmcnt(2)
    ds_read_b64_tr_b16 v[204:205], v223 offset:1024
    ds_read_b64_tr_b16 v[206:207], v223 offset:1536
    v_mfma_f32_32x32x16_bf16 v[48:63], v[196:199], v[64:67], v[48:63]
    s_waitcnt lgkmcnt(2)
    ds_read_b64_tr_b16 v[192:193], v222 offset:2048
    ds_read_b64_tr_b16 v[194:195], v222 offset:2560
    v_mfma_f32_32x32x16_bf16 v[32:47], v[200:203], v[68:71], v[32:47]
    s_waitcnt lgkmcnt(2)
    ds_read_b64_tr_b16 v[196:197], v223 offset:2048
    ds_read_b64_tr_b16 v[198:199], v223 offset:2560
    v_mfma_f32_32x32x16_bf16 v[48:63], v[204:207], v[68:71], v[48:63]
    s_waitcnt lgkmcnt(2)
    ds_read_b64_tr_b16 v[200:201], v222 offset:3072
    ds_read_b64_tr_b16 v[202:203], v222 offset:3584
    v_mfma_f32_32x32x16_bf16 v[32:47], v[192:195], v[72:75], v[32:47]
    s_waitcnt lgkmcnt(2)
    ds_read_b64_tr_b16 v[204:205], v223 offset:3072
    ds_read_b64_tr_b16 v[206:207], v223 offset:3584
    v_mfma_f32_32x32x16_bf16 v[48:63], v[196:199], v[72:75], v[48:63]
    s_waitcnt lgkmcnt(2)
    ds_read_b64_tr_b16 v[192:193], v222 offset:4096
    ds_read_b64_tr_b16 v[194:195], v222 offset:4608
    v_mfma_f32_32x32x16_bf16 v[32:47], v[200:203], v[76:79], v[32:47]
    s_waitcnt lgkmcnt(2)
    ds_read_b64_tr_b16 v[196:197], v223 offset:4096
    ds_read_b64_tr_b16 v[198:199], v223 offset:4608
    v_mfma_f32_32x32x16_bf16 v[48:63], v[204:207], v[76:79], v[48:63]
    s_waitcnt lgkmcnt(2)
    ds_read_b64_tr_b16 v[200:201], v222 offset:5120
    ds_read_b64_tr_b16 v[202:203], v222 offset:5632
    v_mfma_f32_32x32x16_bf16 v[32:47], v[192:195], v[80:83], v[32:47]
    s_waitcnt lgkmcnt(2)
    ds_read_b64_tr_b16 v[204:205], v223 offset:5120
    ds_read_b64_tr_b16 v[206:207], v223 offset:5632
    v_mfma_f32_32x32x16_bf16 v[48:63], v[196:199], v[80:83], v[48:63]
    s_waitcnt lgkmcnt(2)
    ds_read_b64_tr_b16 v[192:193], v222 offset:6144
    ds_read_b64_tr_b16 v[194:195], v222 offset:6656
    v_mfma_f32_32x32x16_bf16 v[32:47], v[200:203], v[84:87], v[32:47]
    s_waitcnt lgkmcnt(2)
    ds_read_b64_tr_b16 v[196:197], v223 offset:6144
    ds_read_b64_tr_b16 v[198:199], v223 offset:6656
    v_mfma_f32_32x32x16_bf16 v[48:63], v[204:207], v[84:87], v[48:63]
    s_waitcnt lgkmcnt(2)
    ds_read_b64_tr_b16 v[200:201], v222 offset:7168
    ds_read_b64_tr_b16 v[202:203], v222 offset:7680
    v_mfma_f32_32x32x16_bf16 v[32:47], v[192:195], v[88:91], v[32:47]
    s_waitcnt lgkmcnt(2)
    ds_read_b64_tr_b16 v[204:205], v223 offset:7168
    ds_read_b64_tr_b16 v[206:207], v223 offset:7680
    v_mfma_f32_32x32x16_bf16 v[48:63], v[196:199], v[88:91], v[48:63]
    s_waitcnt lgkmcnt(2)
    v_mfma_f32_32x32x16_bf16 v[32:47], v[200:203], v[92:95], v[32:47]
    s_waitcnt lgkmcnt(0)
    v_mfma_f32_32x32x16_bf16 v[48:63], v[204:207], v[92:95], v[48:63]
    s_nop 7
    s_nop 3
    v_fma_f32 v16, v231, v48, v16
    v_fma_f32 v17, v231, v49, v17
    v_fma_f32 v18, v231, v50, v18
    v_fma_f32 v19, v231, v51, v19
    v_fma_f32 v20, v231, v52, v20
    v_fma_f32 v21, v231, v53, v21
    v_fma_f32 v22, v231, v54, v22
    v_fma_f32 v23, v231, v55, v23
    v_fma_f32 v24, v231, v56, v24
    v_fma_f32 v25, v231, v57, v25
    v_fma_f32 v26, v231, v58, v26
    v_fma_f32 v27, v231, v59, v27
    v_fma_f32 v28, v231, v60, v28
    v_fma_f32 v29, v231, v61, v29
    v_fma_f32 v30, v231, v62, v30
    v_fma_f32 v31, v231, v63, v31
    ds_write_b128 v209, v[16:19] offset:0
    ds_write_b128 v209, v[20:23] offset:1024
    ds_write_b128 v209, v[24:27] offset:2048
    ds_write_b128 v209, v[28:31] offset:3072
    v_fma_f32 v0, v231, v32, v0
    v_fma_f32 v1, v231, v33, v1
    v_fma_f32 v2, v231, v34, v2
    v_fma_f32 v3, v231, v35, v3
    v_fma_f32 v4, v231, v36, v4
    v_fma_f32 v5, v231, v37, v5
    v_fma_f32 v6, v231, v38, v6
    v_fma_f32 v7, v231, v39, v7
    v_fma_f32 v8, v231, v40, v8
    v_fma_f32 v9, v231, v41, v9
    v_fma_f32 v10, v231, v42, v10
    v_fma_f32 v11, v231, v43, v11
    v_fma_f32 v12, v231, v44, v12
    v_fma_f32 v13, v231, v45, v13
    v_fma_f32 v14, v231, v46, v14
    v_fma_f32 v15, v231, v47, v15
    s_waitcnt lgkmcnt(0)
    s_barrier
    ds_read_b128 v[64:67], v210 offset:0
    ds_read_b128 v[68:71], v210 offset:1024
    ds_read_b128 v[72:75], v210 offset:2048
    ds_read_b128 v[76:79], v210 offset:3072
    s_waitcnt lgkmcnt(0)
    v_add_f32 v0, v0, v64
    v_add_f32 v1, v1, v65
    v_add_f32 v2, v2, v66
    v_add_f32 v3, v3, v67
    v_add_f32 v4, v4, v68
    v_add_f32 v5, v5, v69
    v_add_f32 v6, v6, v70
    v_add_f32 v7, v7, v71
    v_add_f32 v8, v8, v72
    v_add_f32 v9, v9, v73
    v_add_f32 v10, v10, v74
    v_add_f32 v11, v11, v75
    v_add_f32 v12, v12, v76
    v_add_f32 v13, v13, v77
    v_add_f32 v14, v14, v78
    v_add_f32 v15, v15, v79
    v_cvt_pk_bf16_f32 v80, v0, v1
    v_cvt_pk_bf16_f32 v81, v2, v3
    v_cvt_pk_bf16_f32 v82, v4, v5
    v_cvt_pk_bf16_f32 v83, v6, v7
    v_cvt_pk_bf16_f32 v84, v8, v9
    v_cvt_pk_bf16_f32 v85, v10, v11
    v_cvt_pk_bf16_f32 v86, v12, v13
    v_cvt_pk_bf16_f32 v87, v14, v15
    s_nop 1
    v_permlane32_swap_b32 v80, v82
    v_permlane32_swap_b32 v81, v83
    v_permlane32_swap_b32 v84, v86
    v_permlane32_swap_b32 v85, v87
    s_nop 1
    buffer_store_dwordx4 v[80:83], v229, s[16:19], s49 offen offset:0
    buffer_store_dwordx4 v[84:87], v229, s[16:19], s49 offen offset:32
L_end:
    s_endpgm

.section .rodata,"a"
.p2align 6
.amdhsa_kernel gated_mix__mha_block__sliding_local_dilated__prompt_kernel
  .amdhsa_next_free_vgpr 256
  .amdhsa_next_free_sgpr 102
  .amdhsa_accum_offset 256
  .amdhsa_group_segment_fixed_size 0
  .amdhsa_kernarg_size 80
  .amdhsa_user_sgpr_count 2
  .amdhsa_user_sgpr_kernarg_segment_ptr 1
  .amdhsa_system_sgpr_workgroup_id_x 1
  .amdhsa_float_denorm_mode_32 3
.end_amdhsa_kernel
```
